```python
import torch

def _softmax(x, axis=-1):
    return torch.softmax(x, dim=axis)

def _gelu(x):
    return torch.nn.functional.gelu(x, approximate='tanh')

def _silu(x):
    return torch.nn.functional.silu(x)

def _sigmoid(x):
    return torch.sigmoid(x)

def _layernorm(x, axis=-1, eps=1e-05):
    m = x.mean(dim=axis, keepdim=True)
    v = x.var(dim=axis, keepdim=True, unbiased=False)
    return (x - m) / torch.sqrt(v + eps)

def _scatter_add(tgt, idx, src, axis=0):
    return tgt.clone().index_add_(axis, idx, src)

def _segment_sum(src, seg, n):
    out = torch.zeros((n,) + src.shape[1:], dtype=src.dtype)
    return out.index_add_(0, seg, src)

def _pad(x, pw):
    flat = tuple((v for pair in reversed(pw) for v in pair))
    return torch.nn.functional.pad(x, flat)
kernel_name = 'parallel_sum__ssm_conv_s4__mixer_gmlp__prompt'

def setup_inputs():

    _w = lambda a: (lambda t: t.to(torch.bfloat16) if t.is_floating_point() else t)(torch.as_tensor(a))

    def _A_setup():
        B, L, D, N = (1, 2048, 512, 128)
        A_re = -(lambda _x: torch.exp(torch.as_tensor(_x)))((lambda *s: torch.randn(*s, dtype=torch.bfloat16) * 3.2)(D, N))
        A_im = torch.pi * (lambda *s: torch.randn(*s, dtype=torch.bfloat16) * 0.1)(D, N)
        B_re = (lambda *s: torch.randn(*s, dtype=torch.bfloat16) * 0.8)(D, N)
        B_im = (lambda *s: torch.randn(*s, dtype=torch.bfloat16) * 0.8)(D, N)
        C_re = (lambda *s: torch.randn(*s, dtype=torch.bfloat16) * 0.8)(D, N)
        C_im = (lambda *s: torch.randn(*s, dtype=torch.bfloat16) * 0.8)(D, N)
        log_dt = (lambda *s: torch.randn(*s, dtype=torch.bfloat16) * 0.1)(D) * 0.5 - 4.0
        Dskip = (lambda *s: torch.randn(*s, dtype=torch.bfloat16) * 0.8)(D)
        return {'u': _w((lambda *s: torch.randn(*s, dtype=torch.bfloat16) * 0.05)(B, L, D)), 'A_re': _w(A_re), 'A_im': _w(A_im), 'B_re': _w(B_re), 'B_im': _w(B_im), 'C_re': _w(C_re), 'C_im': _w(C_im), 'log_dt': _w(log_dt), 'Dskip': _w(Dskip)}
    _A_in = _A_setup()

    def _B_setup():
        B, S, D, F = (1, 2048, 512, 1792)
        Fh = F // 2
        return {'x': _w((lambda *s: torch.randn(*s, dtype=torch.bfloat16) * 0.05)(B, S, D)), 'w_in': _w((lambda *s: torch.randn(*s, dtype=torch.bfloat16) * 0.4)(D, 2 * Fh)), 'w_sp': _w(0.01 * (lambda *s: torch.randn(*s, dtype=torch.bfloat16) * 0.4)(S, S)), 'b_sp': _w(1.0 + 0.01 * (lambda *s: torch.randn(*s, dtype=torch.bfloat16) * 0.05)(S)), 'w_out': _w((lambda *s: torch.randn(*s, dtype=torch.bfloat16) * 0.05)(Fh, D))}
    _B_in = _B_setup()
    return {'A_u': _A_in['u'], 'A_A_re': _A_in['A_re'], 'A_A_im': _A_in['A_im'], 'A_B_re': _A_in['B_re'], 'A_B_im': _A_in['B_im'], 'A_C_re': _A_in['C_re'], 'A_C_im': _A_in['C_im'], 'A_log_dt': _A_in['log_dt'], 'A_Dskip': _A_in['Dskip'], 'B_x': _B_in['x'], 'B_w_in': _B_in['w_in'], 'B_w_sp': _B_in['w_sp'], 'B_b_sp': _B_in['b_sp'], 'B_w_out': _B_in['w_out']}

def reference(A_u, A_A_re, A_A_im, A_B_re, A_B_im, A_C_re, A_C_im, A_log_dt, A_Dskip, B_x, B_w_in, B_w_sp, B_b_sp, B_w_out):

    def _A_ref(u, A_re, A_im, B_re, B_im, C_re, C_im, log_dt, Dskip):
        Bsz, L, D = u.shape
        dt = torch.exp(log_dt)[:, None]
        A = A_re + 1j * A_im
        Bc = B_re + 1j * B_im
        Cc = C_re + 1j * C_im
        logdA = dt * A
        dB = dt * Bc
        l = (lambda x, dt: x.to(dt))(torch.arange(L), A_re.dtype)
        P = torch.exp(logdA[:, :, None] * l[None, None, :])
        K = torch.einsum('dn,dnl,dn->dl', Cc, P, dB).real
        L2 = 2 * L
        Kp = _pad(K, ((0, 0), (0, L)))
        up = (lambda x, *d: x.permute(*d))(u, 0, 2, 1)
        up = _pad(up, ((0, 0), (0, 0), (0, L)))
        Kf = (lambda x, axes=(-2, -1): torch.fft.rfft2(x.float(), dim=axes))(Kp[:, None, :], axes=(-2, -1))
        Uf = (lambda x, axes=(-2, -1): torch.fft.rfft2(x.float(), dim=axes))(up[:, :, None, :], axes=(-2, -1))
        Yf = Uf * Kf[None, :, :, :]
        y = (lambda x, s, axes=(-2, -1): torch.fft.irfft2(x, s=s, dim=axes).to(torch.bfloat16))(Yf, (1, L2), axes=(-2, -1))[:, :, 0, :L]
        y = (lambda x, *d: x.permute(*d))(y, 0, 2, 1) + u * Dskip[None, None, :]
        return y

    def _B_ref(x, w_in, w_sp, b_sp, w_out):
        B, S, D = x.shape
        F = w_in.shape[-1]
        Fh = F // 2
        z = _gelu(torch.einsum('bsd,df->bsf', x, w_in))
        z1 = z[..., :Fh].clone()
        z2 = _layernorm(z[..., Fh:], axis=-1)
        g = torch.einsum('ts,bsf->btf', w_sp, z2) + b_sp[None, :, None]
        return torch.einsum('bsf,fd->bsd', z1 * g, w_out)
    x = A_u
    xn = _layernorm(x, axis=-1)
    return x + _A_ref(xn, A_A_re, A_A_im, A_B_re, A_B_im, A_C_re, A_C_im, A_log_dt, A_Dskip) + _B_ref(xn, B_w_in, B_w_sp, B_b_sp, B_w_out)
```

```asm
; @launch grid=(256,1,1) block=(512,1,1) lds=163840
.amdgcn_target "amdgcn-amd-amdhsa--gfx950"
.text
.globl parallel_sum__ssm_conv_s4__mixer_gmlp__prompt_kernel
.p2align 8
.type parallel_sum__ssm_conv_s4__mixer_gmlp__prompt_kernel,@function
parallel_sum__ssm_conv_s4__mixer_gmlp__prompt_kernel:
  s_cmp_ge_u32 s2, 256
  s_cbranch_scc1 f_end
  s_load_dwordx2 s[4:5], s[0:1], 0
  s_load_dwordx2 s[6:7], s[0:1], 80
  v_lshrrev_b32 v1, 6, v0
  v_and_b32 v0, 63, v0
  v_readfirstlane_b32 s3, v1
  s_mov_b32 s62, 0x3f803f80
  s_mov_b32 s63, 0xc0135761
  s_mov_b32 s64, 0xbdd2d3e8
  s_and_b32 s12, s2, 7
  s_lshr_b32 s13, s2, 3
  s_lshl_b32 s14, s12, 2
  s_and_b32 s15, s13, 3
  s_add_u32 s14, s14, s15
  s_lshr_b32 s15, s13, 2
  v_lshrrev_b32 v2, 3, v0
  v_and_b32 v3, 7, v0
  v_lshlrev_b32 v4, 4, v3
  v_lshl_add_u32 v4, v2, 10, v4
  s_lshl_b32 s52, s14, 16
  s_lshl_b32 s53, s3, 13
  s_add_u32 s52, s52, s53
  v_lshrrev_b32 v6, 4, v0
  v_and_b32 v7, 15, v0
  s_lshl_b32 s53, s3, 2
  v_add_u32 v16, s53, v6
  s_movk_i32 s53, 3584
  v_mul_u32_u24 v16, s53, v16
  v_lshl_add_u32 v16, v7, 4, v16
  s_lshl_b32 s54, s15, 8
  s_add_u32 s55, s54, 1792
  s_waitcnt lgkmcnt(0)
  s_mov_b32 s16, s4
  s_and_b32 s17, s5, 0xffff
  s_mov_b32 s18, 2097152
  s_mov_b32 s19, 0x00020000
  buffer_load_dwordx4 v[32:35], v4, s[16:19], s52 offen offset:0
  buffer_load_dwordx4 v[36:39], v4, s[16:19], s52 offen offset:128
  buffer_load_dwordx4 v[40:43], v4, s[16:19], s52 offen offset:256
  buffer_load_dwordx4 v[44:47], v4, s[16:19], s52 offen offset:384
  buffer_load_dwordx4 v[48:51], v4, s[16:19], s52 offen offset:512
  buffer_load_dwordx4 v[52:55], v4, s[16:19], s52 offen offset:640
  buffer_load_dwordx4 v[56:59], v4, s[16:19], s52 offen offset:768
  buffer_load_dwordx4 v[60:63], v4, s[16:19], s52 offen offset:896
  s_mov_b32 s20, s6
  s_and_b32 s21, s7, 0xffff
  s_mov_b32 s22, 1835008
  s_mov_b32 s23, 0x00020000
  s_load_dwordx2 s[8:9], s[0:1], 128
  s_load_dwordx2 s[10:11], s[0:1], 120
  s_load_dwordx4 s[40:43], s[0:1], 88
  s_load_dwordx2 s[100:101], s[0:1], 112
  s_load_dwordx4 s[68:71], s[0:1], 8
  s_load_dwordx4 s[72:75], s[0:1], 24
  s_load_dwordx4 s[76:79], s[0:1], 40
  s_load_dwordx4 s[80:83], s[0:1], 56
  s_waitcnt lgkmcnt(0)
  s_mov_b32 s24, s8
  s_and_b32 s25, s9, 0xffff
  s_mov_b32 s26, 4194304
  s_mov_b32 s27, 0x00020000
  s_add_u32 s28, s8, 4194304
  s_addc_u32 s29, s9, 0
  s_and_b32 s29, s29, 0xffff
  s_mov_b32 s30, 4194304
  s_mov_b32 s31, 0x00020000
  s_add_u32 s32, s8, 26214400
  s_addc_u32 s33, s9, 0
  s_and_b32 s33, s33, 0xffff
  s_mov_b32 s34, 917504
  s_mov_b32 s35, 0x00020000
  s_mov_b32 s36, s40
  s_and_b32 s37, s41, 0xffff
  s_mov_b32 s38, 8388608
  s_mov_b32 s39, 0x00020000
  s_add_u32 s44, s8, 33554432
  s_addc_u32 s45, s9, 0
  s_and_b32 s45, s45, 0xffff
  s_mov_b32 s46, 8388608
  s_mov_b32 s47, 0x00020000
  s_and_b32 s53, s3, 1
  s_lshl_b32 s53, s53, 3
  v_add_u32 v5, s53, v2
  v_xor_b32 v5, v5, v3
  v_lshlrev_b32 v5, 4, v5
  v_lshl_add_u32 v5, v2, 10, v5
  s_lshl_b32 s53, s3, 13
  s_add_u32 s53, s53, 98304
  v_add_u32 v23, s53, v5
  v_xor_b32 v24, 128, v23
  s_cmp_eq_u32 s15, 7
  s_cbranch_scc1 k1_aux
  s_add_u32 s57, s55, 0
  buffer_load_dwordx4 v[96:99], v16, s[20:23], s57 offen
  s_add_u32 s57, s55, 114688
  buffer_load_dwordx4 v[100:103], v16, s[20:23], s57 offen
  s_add_u32 s57, s55, 229376
  buffer_load_dwordx4 v[104:107], v16, s[20:23], s57 offen
  s_add_u32 s57, s55, 344064
  buffer_load_dwordx4 v[108:111], v16, s[20:23], s57 offen
  s_mov_b32 s53, 0
  v_mov_b32 v13, s53
  s_or_b32 s53, s2, s3
  s_cmp_lg_u32 s53, 0
  s_cbranch_scc1 k1_nolead
  s_memrealtime s[96:97]
  s_waitcnt lgkmcnt(0)
  s_or_b32 s96, s96, 1
  v_mov_b32 v14, s96
  v_mov_b32 v15, s97
  s_mov_b64 exec, 1
  global_store_dwordx2 v13, v[14:15], s[10:11] sc0 sc1
  s_mov_b64 exec, -1
k1_nolead:
  v_lshlrev_b32 v2, 2, v6
  v_xor_b32 v2, v2, v7
  v_lshlrev_b32 v2, 4, v2
  v_lshl_add_u32 v2, v6, 8, v2
  s_lshl_b32 s53, s3, 10
  v_add_u32 v17, s53, v2
  v_add_u32 v18, 0x10000, v17
  s_lshr_b32 s59, s3, 2
  s_and_b32 s58, s3, 3
  v_lshrrev_b32 v2, 4, v0
  v_bfe_u32 v3, v0, 2, 2
  v_and_b32 v4, 3, v0
  v_and_b32 v5, 1, v2
  v_lshl_add_u32 v4, v5, 2, v4
  v_lshrrev_b32 v5, 1, v4
  v_and_b32 v6, 1, v4
  v_lshrrev_b32 v2, 1, v2
  v_lshl_add_u32 v2, v2, 3, v3
  v_lshlrev_b32 v2, 8, v2
  v_lshlrev_b32 v3, 6, v3
  s_lshl_b32 s53, s58, 6
  v_lshlrev_b32 v7, 5, v6
  v_lshl_add_u32 v7, v5, 3, v7
  v_add_u32 v7, s53, v7
  v_xor_b32 v7, v7, v3
  v_add_u32 v19, v7, v2
  v_add_u32 v20, 0x10000, v19
  v_and_b32 v7, 1, v5
  v_lshlrev_b32 v7, 5, v7
  v_lshl_add_u32 v7, v6, 4, v7
  v_lshrrev_b32 v5, 1, v5
  v_lshl_add_u32 v7, v5, 3, v7
  v_add_u32 v7, s53, v7
  v_xor_b32 v7, v7, v3
  v_add_u32 v21, v7, v2
  v_add_u32 v22, 0x10000, v21
  v_and_b32 v2, 31, v0
  v_lshrrev_b32 v3, 5, v0
  v_and_b32 v4, 15, v0
  v_xor_b32 v3, v3, v4
  v_lshlrev_b32 v3, 4, v3
  v_lshl_add_u32 v3, v2, 10, v3
  s_lshl_b32 s53, s59, 15
  s_add_u32 s53, s53, 98304
  v_add_u32 v1, s53, v3
  v_lshlrev_b32 v2, 2, v2
  s_lshl_b32 s53, s59, 7
  s_add_u32 s53, s53, 65536
  v_add_u32 v28, s53, v2
  v_lshrrev_b32 v2, 3, v0
  v_lshlrev_b32 v2, 2, v2
  s_lshl_b32 s53, s3, 5
  s_add_u32 s53, s53, 65536
  v_add_u32 v29, s53, v2
  v_mov_b32 v8, 0
  v_mov_b32 v9, 0
  v_mov_b32 v10, 0
  v_mov_b32 v11, 0
  s_waitcnt vmcnt(11)
  v_dot2c_f32_bf16 v8, s62, v32
  v_dot2c_f32_bf16 v10, s62, v33
  v_dot2c_f32_bf16 v8, s62, v34
  v_dot2c_f32_bf16 v10, s62, v35
  s_waitcnt vmcnt(10)
  v_dot2c_f32_bf16 v8, s62, v36
  v_dot2c_f32_bf16 v10, s62, v37
  v_dot2c_f32_bf16 v8, s62, v38
  v_dot2c_f32_bf16 v10, s62, v39
  s_add_u32 s57, s55, 458752
  buffer_load_dwordx4 v[112:115], v16, s[20:23], s57 offen
  s_waitcnt vmcnt(10)
  v_dot2c_f32_bf16 v8, s62, v40
  v_dot2c_f32_bf16 v10, s62, v41
  v_dot2c_f32_bf16 v8, s62, v42
  v_dot2c_f32_bf16 v10, s62, v43
  s_waitcnt vmcnt(9)
  v_dot2c_f32_bf16 v8, s62, v44
  v_dot2c_f32_bf16 v10, s62, v45
  v_dot2c_f32_bf16 v8, s62, v46
  v_dot2c_f32_bf16 v10, s62, v47
  s_add_u32 s57, s55, 573440
  buffer_load_dwordx4 v[116:119], v16, s[20:23], s57 offen
  s_waitcnt vmcnt(9)
  v_dot2c_f32_bf16 v8, s62, v48
  v_dot2c_f32_bf16 v10, s62, v49
  v_dot2c_f32_bf16 v8, s62, v50
  v_dot2c_f32_bf16 v10, s62, v51
  s_waitcnt vmcnt(8)
  v_dot2c_f32_bf16 v8, s62, v52
  v_dot2c_f32_bf16 v10, s62, v53
  v_dot2c_f32_bf16 v8, s62, v54
  v_dot2c_f32_bf16 v10, s62, v55
  s_add_u32 s57, s55, 688128
  buffer_load_dwordx4 v[120:123], v16, s[20:23], s57 offen
  s_waitcnt vmcnt(8)
  v_dot2c_f32_bf16 v8, s62, v56
  v_dot2c_f32_bf16 v10, s62, v57
  v_dot2c_f32_bf16 v8, s62, v58
  v_dot2c_f32_bf16 v10, s62, v59
  s_waitcnt vmcnt(7)
  v_dot2c_f32_bf16 v8, s62, v60
  v_dot2c_f32_bf16 v10, s62, v61
  v_dot2c_f32_bf16 v8, s62, v62
  v_dot2c_f32_bf16 v10, s62, v63
  s_add_u32 s57, s55, 802816
  buffer_load_dwordx4 v[124:127], v16, s[20:23], s57 offen
  s_nop 0
  v_add_f32 v8, v8, v10
  s_nop 1
  v_add_f32_dpp v8, v8, v8 quad_perm:[1,0,3,2] row_mask:0xf bank_mask:0xf
  s_nop 1
  v_add_f32_dpp v8, v8, v8 quad_perm:[2,3,0,1] row_mask:0xf bank_mask:0xf
  s_nop 1
  v_add_f32_dpp v8, v8, v8 row_half_mirror row_mask:0xf bank_mask:0xf
  v_mul_f32 v8, 0xbb000000, v8
  v_cvt_pk_bf16_f32 v12, v8, v8
  v_lshlrev_b32 v10, 16, v12
  s_mov_b32 s65, 0xffff0000
  s_movk_i32 s66, 0x3f80
  v_dot2_f32_bf16 v2, v32, s66, v10
  v_and_b32 v3, s65, v32
  v_add_f32 v3, v3, v10
  v_dot2_f32_bf16 v4, v33, s66, v10
  v_and_b32 v5, s65, v33
  v_add_f32 v5, v5, v10
  v_cvt_pk_bf16_f32 v32, v2, v3
  v_dot2_f32_bf16 v6, v34, s66, v10
  v_and_b32 v7, s65, v34
  v_add_f32 v7, v7, v10
  v_cvt_pk_bf16_f32 v33, v4, v5
  v_dot2_f32_bf16 v2, v35, s66, v10
  v_and_b32 v3, s65, v35
  v_add_f32 v3, v3, v10
  v_cvt_pk_bf16_f32 v34, v6, v7
  s_add_u32 s57, s55, 917504
  buffer_load_dwordx4 v[80:83], v16, s[20:23], s57 offen
  v_cvt_pk_bf16_f32 v35, v2, v3
  ds_write_b128 v23, v[32:35] offset:0
  v_dot2_f32_bf16 v4, v36, s66, v10
  v_and_b32 v5, s65, v36
  v_add_f32 v5, v5, v10
  v_dot2_f32_bf16 v6, v37, s66, v10
  v_and_b32 v7, s65, v37
  v_add_f32 v7, v7, v10
  v_cvt_pk_bf16_f32 v36, v4, v5
  v_dot2_f32_bf16 v2, v38, s66, v10
  v_and_b32 v3, s65, v38
  v_add_f32 v3, v3, v10
  v_cvt_pk_bf16_f32 v37, v6, v7
  v_dot2_f32_bf16 v4, v39, s66, v10
  v_and_b32 v5, s65, v39
  v_add_f32 v5, v5, v10
  v_cvt_pk_bf16_f32 v38, v2, v3
  s_add_u32 s57, s55, 1032192
  buffer_load_dwordx4 v[84:87], v16, s[20:23], s57 offen
  v_cvt_pk_bf16_f32 v39, v4, v5
  ds_write_b128 v24, v[36:39] offset:0
  v_dot2_f32_bf16 v6, v40, s66, v10
  v_and_b32 v7, s65, v40
  v_add_f32 v7, v7, v10
  v_dot2_f32_bf16 v2, v41, s66, v10
  v_and_b32 v3, s65, v41
  v_add_f32 v3, v3, v10
  v_cvt_pk_bf16_f32 v40, v6, v7
  v_dot2_f32_bf16 v4, v42, s66, v10
  v_and_b32 v5, s65, v42
  v_add_f32 v5, v5, v10
  v_cvt_pk_bf16_f32 v41, v2, v3
  v_dot2_f32_bf16 v6, v43, s66, v10
  v_and_b32 v7, s65, v43
  v_add_f32 v7, v7, v10
  v_cvt_pk_bf16_f32 v42, v4, v5
  s_add_u32 s57, s55, 1146880
  buffer_load_dwordx4 v[88:91], v16, s[20:23], s57 offen
  v_cvt_pk_bf16_f32 v43, v6, v7
  ds_write_b128 v23, v[40:43] offset:256
  v_dot2_f32_bf16 v2, v44, s66, v10
  v_and_b32 v3, s65, v44
  v_add_f32 v3, v3, v10
  v_dot2_f32_bf16 v4, v45, s66, v10
  v_and_b32 v5, s65, v45
  v_add_f32 v5, v5, v10
  v_cvt_pk_bf16_f32 v44, v2, v3
  v_dot2_f32_bf16 v6, v46, s66, v10
  v_and_b32 v7, s65, v46
  v_add_f32 v7, v7, v10
  v_cvt_pk_bf16_f32 v45, v4, v5
  v_dot2_f32_bf16 v2, v47, s66, v10
  v_and_b32 v3, s65, v47
  v_add_f32 v3, v3, v10
  v_cvt_pk_bf16_f32 v46, v6, v7
  s_add_u32 s57, s55, 1261568
  buffer_load_dwordx4 v[92:95], v16, s[20:23], s57 offen
  v_cvt_pk_bf16_f32 v47, v2, v3
  ds_write_b128 v24, v[44:47] offset:256
  v_dot2_f32_bf16 v4, v48, s66, v10
  v_and_b32 v5, s65, v48
  v_add_f32 v5, v5, v10
  v_dot2_f32_bf16 v6, v49, s66, v10
  v_and_b32 v7, s65, v49
  v_add_f32 v7, v7, v10
  v_cvt_pk_bf16_f32 v48, v4, v5
  v_dot2_f32_bf16 v2, v50, s66, v10
  v_and_b32 v3, s65, v50
  v_add_f32 v3, v3, v10
  v_cvt_pk_bf16_f32 v49, v6, v7
  v_dot2_f32_bf16 v4, v51, s66, v10
  v_and_b32 v5, s65, v51
  v_add_f32 v5, v5, v10
  v_cvt_pk_bf16_f32 v50, v2, v3
  s_add_u32 s57, s55, 1376256
  buffer_load_dwordx4 v[128:131], v16, s[20:23], s57 offen
  v_cvt_pk_bf16_f32 v51, v4, v5
  ds_write_b128 v23, v[48:51] offset:512
  v_dot2_f32_bf16 v6, v52, s66, v10
  v_and_b32 v7, s65, v52
  v_add_f32 v7, v7, v10
  v_dot2_f32_bf16 v2, v53, s66, v10
  v_and_b32 v3, s65, v53
  v_add_f32 v3, v3, v10
  v_cvt_pk_bf16_f32 v52, v6, v7
  v_dot2_f32_bf16 v4, v54, s66, v10
  v_and_b32 v5, s65, v54
  v_add_f32 v5, v5, v10
  v_cvt_pk_bf16_f32 v53, v2, v3
  v_dot2_f32_bf16 v6, v55, s66, v10
  v_and_b32 v7, s65, v55
  v_add_f32 v7, v7, v10
  v_cvt_pk_bf16_f32 v54, v4, v5
  s_add_u32 s57, s55, 1490944
  buffer_load_dwordx4 v[132:135], v16, s[20:23], s57 offen
  v_cvt_pk_bf16_f32 v55, v6, v7
  ds_write_b128 v24, v[52:55] offset:512
  v_dot2_f32_bf16 v2, v56, s66, v10
  v_and_b32 v3, s65, v56
  v_add_f32 v3, v3, v10
  v_dot2_f32_bf16 v4, v57, s66, v10
  v_and_b32 v5, s65, v57
  v_add_f32 v5, v5, v10
  v_cvt_pk_bf16_f32 v56, v2, v3
  v_dot2_f32_bf16 v6, v58, s66, v10
  v_and_b32 v7, s65, v58
  v_add_f32 v7, v7, v10
  v_cvt_pk_bf16_f32 v57, v4, v5
  v_dot2_f32_bf16 v2, v59, s66, v10
  v_and_b32 v3, s65, v59
  v_add_f32 v3, v3, v10
  v_cvt_pk_bf16_f32 v58, v6, v7
  s_add_u32 s57, s55, 1605632
  buffer_load_dwordx4 v[136:139], v16, s[20:23], s57 offen
  v_cvt_pk_bf16_f32 v59, v2, v3
  ds_write_b128 v23, v[56:59] offset:768
  v_dot2_f32_bf16 v4, v60, s66, v10
  v_and_b32 v5, s65, v60
  v_add_f32 v5, v5, v10
  v_dot2_f32_bf16 v6, v61, s66, v10
  v_and_b32 v7, s65, v61
  v_add_f32 v7, v7, v10
  v_cvt_pk_bf16_f32 v60, v4, v5
  v_dot2_f32_bf16 v2, v62, s66, v10
  v_and_b32 v3, s65, v62
  v_add_f32 v3, v3, v10
  v_cvt_pk_bf16_f32 v61, v6, v7
  v_dot2_f32_bf16 v4, v63, s66, v10
  v_and_b32 v5, s65, v63
  v_add_f32 v5, v5, v10
  v_cvt_pk_bf16_f32 v62, v2, v3
  s_add_u32 s57, s55, 1720320
  buffer_load_dwordx4 v[140:143], v16, s[20:23], s57 offen
  v_cvt_pk_bf16_f32 v63, v4, v5
  ds_write_b128 v24, v[60:63] offset:768
  s_waitcnt vmcnt(15)
  ds_write_b128 v17, v[96:99] offset:0
  s_waitcnt vmcnt(14)
  ds_write_b128 v17, v[100:103] offset:8192
  s_waitcnt vmcnt(13)
  ds_write_b128 v17, v[104:107] offset:16384
  s_waitcnt vmcnt(12)
  ds_write_b128 v17, v[108:111] offset:24576
  v_dot2c_f32_bf16 v9, v32, v32
  v_dot2c_f32_bf16 v11, v33, v33
  v_dot2c_f32_bf16 v9, v34, v34
  v_dot2c_f32_bf16 v11, v35, v35
  v_dot2c_f32_bf16 v9, v36, v36
  v_dot2c_f32_bf16 v11, v37, v37
  v_dot2c_f32_bf16 v9, v38, v38
  v_dot2c_f32_bf16 v11, v39, v39
  v_dot2c_f32_bf16 v9, v40, v40
  v_dot2c_f32_bf16 v11, v41, v41
  v_dot2c_f32_bf16 v9, v42, v42
  v_dot2c_f32_bf16 v11, v43, v43
  v_dot2c_f32_bf16 v9, v44, v44
  v_dot2c_f32_bf16 v11, v45, v45
  v_dot2c_f32_bf16 v9, v46, v46
  v_dot2c_f32_bf16 v11, v47, v47
  v_dot2c_f32_bf16 v9, v48, v48
  v_dot2c_f32_bf16 v11, v49, v49
  v_dot2c_f32_bf16 v9, v50, v50
  v_dot2c_f32_bf16 v11, v51, v51
  v_dot2c_f32_bf16 v9, v52, v52
  v_dot2c_f32_bf16 v11, v53, v53
  v_dot2c_f32_bf16 v9, v54, v54
  v_dot2c_f32_bf16 v11, v55, v55
  v_dot2c_f32_bf16 v9, v56, v56
  v_dot2c_f32_bf16 v11, v57, v57
  v_dot2c_f32_bf16 v9, v58, v58
  v_dot2c_f32_bf16 v11, v59, v59
  v_dot2c_f32_bf16 v9, v60, v60
  v_dot2c_f32_bf16 v11, v61, v61
  v_dot2c_f32_bf16 v9, v62, v62
  v_dot2c_f32_bf16 v11, v63, v63
  s_nop 2
  v_add_f32 v9, v9, v11
  s_nop 1
  v_add_f32_dpp v9, v9, v9 quad_perm:[1,0,3,2] row_mask:0xf bank_mask:0xf
  s_nop 1
  v_add_f32_dpp v9, v9, v9 quad_perm:[2,3,0,1] row_mask:0xf bank_mask:0xf
  s_nop 1
  v_add_f32_dpp v9, v9, v9 row_half_mirror row_mask:0xf bank_mask:0xf
  v_sub_f32 v8, v8, v10
  v_mul_f32 v9, 0x3b000000, v9
  v_fma_f32 v9, -v8, v8, v9
  v_max_f32 v9, 0, v9
  v_cvt_pk_bf16_f32 v10, v9, v9
  v_lshlrev_b32 v9, 16, v10
  v_add_f32 v9, 0x3727c5ac, v9
  v_cvt_pk_bf16_f32 v10, v9, v9
  v_lshlrev_b32 v9, 16, v10
  v_sqrt_f32 v9, v9
  s_nop 0
  v_cvt_pk_bf16_f32 v10, v9, v9
  v_lshlrev_b32 v9, 16, v10
  v_rcp_f32 v9, v9
  s_nop 0
  ds_write_b32 v29, v9
  s_waitcnt lgkmcnt(0)
  s_barrier
  ds_read_b64_tr_b16 v[96:97], v19 offset:0
  ds_read_b64_tr_b16 v[98:99], v19 offset:1024
  ds_read_b64_tr_b16 v[100:101], v19 offset:4096
  ds_read_b64_tr_b16 v[102:103], v19 offset:5120
  ds_read_b64_tr_b16 v[104:105], v19 offset:8192
  ds_read_b64_tr_b16 v[106:107], v19 offset:9216
  ds_read_b64_tr_b16 v[108:109], v19 offset:12288
  ds_read_b64_tr_b16 v[110:111], v19 offset:13312
  ds_read_b32 v28, v28
  v_xor_b32 v2, 0, v1
  ds_read_b128 a[0:3], v2 offset:0
  ds_read_b128 a[32:35], v2 offset:256
  v_xor_b32 v3, 32, v1
  ds_read_b128 a[4:7], v3 offset:0
  ds_read_b128 a[36:39], v3 offset:256
  v_xor_b32 v2, 64, v1
  ds_read_b128 a[8:11], v2 offset:0
  ds_read_b128 a[40:43], v2 offset:256
  v_xor_b32 v3, 96, v1
  ds_read_b128 a[12:15], v3 offset:0
  ds_read_b128 a[44:47], v3 offset:256
  v_xor_b32 v2, 128, v1
  ds_read_b128 a[16:19], v2 offset:0
  ds_read_b128 a[48:51], v2 offset:256
  s_waitcnt vmcnt(11)
  ds_write_b128 v17, v[112:115] offset:32768
  v_xor_b32 v3, 160, v1
  ds_read_b128 a[20:23], v3 offset:0
  ds_read_b128 a[52:55], v3 offset:256
  s_waitcnt vmcnt(10)
  ds_write_b128 v17, v[116:119] offset:40960
  v_xor_b32 v2, 192, v1
  ds_read_b128 a[24:27], v2 offset:0
  ds_read_b128 a[56:59], v2 offset:256
  s_waitcnt vmcnt(9)
  ds_write_b128 v17, v[120:123] offset:49152
  v_xor_b32 v3, 224, v1
  ds_read_b128 a[28:31], v3 offset:0
  ds_read_b128 a[60:63], v3 offset:256
  s_waitcnt vmcnt(8)
  ds_write_b128 v17, v[124:127] offset:57344
  s_waitcnt lgkmcnt(0)
  v_mfma_f32_32x32x16_bf16 v[64:79], v[96:99], a[0:3], 0
  ds_read_b64_tr_b16 v[112:113], v19 offset:16384
  ds_read_b64_tr_b16 v[114:115], v19 offset:17408
  ds_read_b64_tr_b16 v[116:117], v19 offset:20480
  ds_read_b64_tr_b16 v[118:119], v19 offset:21504
  ds_read_b64_tr_b16 v[120:121], v19 offset:24576
  ds_read_b64_tr_b16 v[122:123], v19 offset:25600
  ds_read_b64_tr_b16 v[124:125], v19 offset:28672
  ds_read_b64_tr_b16 v[126:127], v19 offset:29696
  v_xor_b32 v2, 0, v1
  ds_read_b128 a[64:67], v2 offset:512
  v_mfma_f32_32x32x16_bf16 v[64:79], v[100:103], a[4:7], v[64:79]
  v_xor_b32 v3, 32, v1
  ds_read_b128 a[68:71], v3 offset:512
  s_add_u32 s57, s54, 0
  buffer_load_dwordx4 v[32:35], v16, s[20:23], s57 offen
  v_mfma_f32_32x32x16_bf16 v[64:79], v[104:107], a[8:11], v[64:79]
  v_xor_b32 v2, 64, v1
  ds_read_b128 a[72:75], v2 offset:512
  v_mfma_f32_32x32x16_bf16 v[64:79], v[108:111], a[12:15], v[64:79]
  v_xor_b32 v3, 96, v1
  ds_read_b128 a[76:79], v3 offset:512
  s_add_u32 s57, s54, 114688
  buffer_load_dwordx4 v[36:39], v16, s[20:23], s57 offen
  s_waitcnt lgkmcnt(0)
  s_barrier
  v_mfma_f32_32x32x16_bf16 v[64:79], v[112:115], a[16:19], v[64:79]
  ds_read_b64_tr_b16 v[96:97], v19 offset:32768
  ds_read_b64_tr_b16 v[98:99], v19 offset:33792
  ds_read_b64_tr_b16 v[100:101], v19 offset:36864
  ds_read_b64_tr_b16 v[102:103], v19 offset:37888
  ds_read_b64_tr_b16 v[104:105], v19 offset:40960
  ds_read_b64_tr_b16 v[106:107], v19 offset:41984
  ds_read_b64_tr_b16 v[108:109], v19 offset:45056
  ds_read_b64_tr_b16 v[110:111], v19 offset:46080
  v_xor_b32 v2, 128, v1
  ds_read_b128 a[80:83], v2 offset:512
  v_mfma_f32_32x32x16_bf16 v[64:79], v[116:119], a[20:23], v[64:79]
  s_waitcnt vmcnt(9)
  ds_write_b128 v18, v[80:83] offset:0
  v_xor_b32 v3, 160, v1
  ds_read_b128 a[84:87], v3 offset:512
  s_add_u32 s57, s54, 229376
  buffer_load_dwordx4 v[40:43], v16, s[20:23], s57 offen
  v_mfma_f32_32x32x16_bf16 v[64:79], v[120:123], a[24:27], v[64:79]
  s_waitcnt vmcnt(9)
  ds_write_b128 v18, v[84:87] offset:8192
  v_xor_b32 v2, 192, v1
  ds_read_b128 a[88:91], v2 offset:512
  v_mfma_f32_32x32x16_bf16 v[64:79], v[124:127], a[28:31], v[64:79]
  v_xor_b32 v3, 224, v1
  ds_read_b128 a[92:95], v3 offset:512
  s_add_u32 s57, s54, 344064
  buffer_load_dwordx4 v[44:47], v16, s[20:23], s57 offen
  s_waitcnt lgkmcnt(0)
  v_mfma_f32_32x32x16_bf16 v[64:79], v[96:99], a[32:35], v[64:79]
  ds_read_b64_tr_b16 v[112:113], v19 offset:49152
  ds_read_b64_tr_b16 v[114:115], v19 offset:50176
  ds_read_b64_tr_b16 v[116:117], v19 offset:53248
  ds_read_b64_tr_b16 v[118:119], v19 offset:54272
  ds_read_b64_tr_b16 v[120:121], v19 offset:57344
  ds_read_b64_tr_b16 v[122:123], v19 offset:58368
  ds_read_b64_tr_b16 v[124:125], v19 offset:61440
  ds_read_b64_tr_b16 v[126:127], v19 offset:62464
  v_xor_b32 v2, 0, v1
  ds_read_b128 a[96:99], v2 offset:768
  v_mfma_f32_32x32x16_bf16 v[64:79], v[100:103], a[36:39], v[64:79]
  s_waitcnt vmcnt(9)
  ds_write_b128 v18, v[88:91] offset:16384
  v_xor_b32 v3, 32, v1
  ds_read_b128 a[100:103], v3 offset:768
  s_add_u32 s57, s54, 458752
  buffer_load_dwordx4 v[48:51], v16, s[20:23], s57 offen
  v_mfma_f32_32x32x16_bf16 v[64:79], v[104:107], a[40:43], v[64:79]
  s_waitcnt vmcnt(9)
  ds_write_b128 v18, v[92:95] offset:24576
  v_xor_b32 v2, 64, v1
  ds_read_b128 a[104:107], v2 offset:768
  v_mfma_f32_32x32x16_bf16 v[64:79], v[108:111], a[44:47], v[64:79]
  v_xor_b32 v3, 96, v1
  ds_read_b128 a[108:111], v3 offset:768
  s_add_u32 s57, s54, 573440
  buffer_load_dwordx4 v[52:55], v16, s[20:23], s57 offen
  s_waitcnt lgkmcnt(0)
  s_barrier
  v_mfma_f32_32x32x16_bf16 v[64:79], v[112:115], a[48:51], v[64:79]
  ds_read_b64_tr_b16 v[96:97], v20 offset:0
  ds_read_b64_tr_b16 v[98:99], v20 offset:1024
  ds_read_b64_tr_b16 v[100:101], v20 offset:4096
  ds_read_b64_tr_b16 v[102:103], v20 offset:5120
  ds_read_b64_tr_b16 v[104:105], v20 offset:8192
  ds_read_b64_tr_b16 v[106:107], v20 offset:9216
  ds_read_b64_tr_b16 v[108:109], v20 offset:12288
  ds_read_b64_tr_b16 v[110:111], v20 offset:13312
  v_mfma_f32_32x32x16_bf16 v[64:79], v[116:119], a[52:55], v[64:79]
  s_waitcnt vmcnt(9)
  ds_write_b128 v17, v[128:131] offset:0
  s_add_u32 s57, s54, 688128
  buffer_load_dwordx4 v[56:59], v16, s[20:23], s57 offen
  v_mfma_f32_32x32x16_bf16 v[64:79], v[120:123], a[56:59], v[64:79]
  s_waitcnt vmcnt(9)
  ds_write_b128 v17, v[132:135] offset:8192
  v_mfma_f32_32x32x16_bf16 v[64:79], v[124:127], a[60:63], v[64:79]
  s_add_u32 s57, s54, 802816
  buffer_load_dwordx4 v[60:63], v16, s[20:23], s57 offen
  s_waitcnt lgkmcnt(0)
  v_mfma_f32_32x32x16_bf16 v[64:79], v[96:99], a[64:67], v[64:79]
  ds_read_b64_tr_b16 v[112:113], v20 offset:16384
  ds_read_b64_tr_b16 v[114:115], v20 offset:17408
  ds_read_b64_tr_b16 v[116:117], v20 offset:20480
  ds_read_b64_tr_b16 v[118:119], v20 offset:21504
  ds_read_b64_tr_b16 v[120:121], v20 offset:24576
  ds_read_b64_tr_b16 v[122:123], v20 offset:25600
  ds_read_b64_tr_b16 v[124:125], v20 offset:28672
  ds_read_b64_tr_b16 v[126:127], v20 offset:29696
  v_mfma_f32_32x32x16_bf16 v[64:79], v[100:103], a[68:71], v[64:79]
  s_waitcnt vmcnt(9)
  ds_write_b128 v17, v[136:139] offset:16384
  v_mfma_f32_32x32x16_bf16 v[64:79], v[104:107], a[72:75], v[64:79]
  s_waitcnt vmcnt(8)
  ds_write_b128 v17, v[140:143] offset:24576
  v_mfma_f32_32x32x16_bf16 v[64:79], v[108:111], a[76:79], v[64:79]
  s_waitcnt lgkmcnt(0)
  s_barrier
  v_mfma_f32_32x32x16_bf16 v[64:79], v[112:115], a[80:83], v[64:79]
  ds_read_b64_tr_b16 v[96:97], v19 offset:0
  ds_read_b64_tr_b16 v[98:99], v19 offset:1024
  ds_read_b64_tr_b16 v[100:101], v19 offset:4096
  ds_read_b64_tr_b16 v[102:103], v19 offset:5120
  ds_read_b64_tr_b16 v[104:105], v19 offset:8192
  ds_read_b64_tr_b16 v[106:107], v19 offset:9216
  ds_read_b64_tr_b16 v[108:109], v19 offset:12288
  ds_read_b64_tr_b16 v[110:111], v19 offset:13312
  v_xor_b32 v2, 128, v1
  ds_read_b128 v[128:131], v2 offset:768
  v_mfma_f32_32x32x16_bf16 v[64:79], v[116:119], a[84:87], v[64:79]
  s_waitcnt vmcnt(7)
  ds_write_b128 v17, v[32:35] offset:32768
  v_xor_b32 v3, 160, v1
  ds_read_b128 v[132:135], v3 offset:768
  v_mfma_f32_32x32x16_bf16 v[64:79], v[120:123], a[88:91], v[64:79]
  s_waitcnt vmcnt(6)
  ds_write_b128 v17, v[36:39] offset:40960
  v_xor_b32 v2, 192, v1
  ds_read_b128 v[136:139], v2 offset:768
  v_mfma_f32_32x32x16_bf16 v[64:79], v[124:127], a[92:95], v[64:79]
  v_xor_b32 v3, 224, v1
  ds_read_b128 v[140:143], v3 offset:768
  global_load_dwordx2 v[14:15], v13, s[10:11] sc0 sc1
  s_waitcnt lgkmcnt(0)
  v_mfma_f32_32x32x16_bf16 v[64:79], v[96:99], a[96:99], v[64:79]
  ds_read_b64_tr_b16 v[112:113], v19 offset:16384
  ds_read_b64_tr_b16 v[114:115], v19 offset:17408
  ds_read_b64_tr_b16 v[116:117], v19 offset:20480
  ds_read_b64_tr_b16 v[118:119], v19 offset:21504
  ds_read_b64_tr_b16 v[120:121], v19 offset:24576
  ds_read_b64_tr_b16 v[122:123], v19 offset:25600
  ds_read_b64_tr_b16 v[124:125], v19 offset:28672
  ds_read_b64_tr_b16 v[126:127], v19 offset:29696
  s_add_u32 s57, s54, 917504
  buffer_load_dwordx4 v[32:35], v16, s[20:23], s57 offen
  v_mfma_f32_32x32x16_bf16 v[64:79], v[100:103], a[100:103], v[64:79]
  s_waitcnt vmcnt(7)
  ds_write_b128 v17, v[40:43] offset:49152
  s_add_u32 s57, s54, 1032192
  buffer_load_dwordx4 v[36:39], v16, s[20:23], s57 offen
  v_mfma_f32_32x32x16_bf16 v[64:79], v[104:107], a[104:107], v[64:79]
  s_waitcnt vmcnt(7)
  ds_write_b128 v17, v[44:47] offset:57344
  v_mfma_f32_32x32x16_bf16 v[64:79], v[108:111], a[108:111], v[64:79]
  s_waitcnt lgkmcnt(0)
  s_barrier
  v_mfma_f32_32x32x16_bf16 v[64:79], v[112:115], v[128:131], v[64:79]
  ds_read_b64_tr_b16 v[96:97], v21 offset:32768
  ds_read_b64_tr_b16 v[98:99], v21 offset:33792
  ds_read_b64_tr_b16 v[100:101], v21 offset:36864
  ds_read_b64_tr_b16 v[102:103], v21 offset:37888
  ds_read_b64_tr_b16 v[104:105], v21 offset:40960
  ds_read_b64_tr_b16 v[106:107], v21 offset:41984
  ds_read_b64_tr_b16 v[108:109], v21 offset:45056
  ds_read_b64_tr_b16 v[110:111], v21 offset:46080
  s_add_u32 s57, s54, 1146880
  buffer_load_dwordx4 v[40:43], v16, s[20:23], s57 offen
  v_mfma_f32_32x32x16_bf16 v[64:79], v[116:119], v[132:135], v[64:79]
  s_waitcnt vmcnt(7)
  ds_write_b128 v18, v[48:51] offset:0
  s_add_u32 s57, s54, 1261568
  buffer_load_dwordx4 v[44:47], v16, s[20:23], s57 offen
  v_mfma_f32_32x32x16_bf16 v[64:79], v[120:123], v[136:139], v[64:79]
  s_waitcnt vmcnt(7)
  ds_write_b128 v18, v[52:55] offset:8192
  v_mfma_f32_32x32x16_bf16 v[64:79], v[124:127], v[140:143], v[64:79]
  v_mul_f32 v12, s63, v28
  v_mul_f32 v23, v28, v28
  v_mul_f32 v23, v23, v28
  v_mul_f32 v23, s64, v23
  v_rcp_f32 v24, v28
  s_waitcnt lgkmcnt(0)
  v_mfma_f32_32x32x16_bf16 v[80:95], v[96:99], a[0:3], 0
  ds_read_b64_tr_b16 v[112:113], v21 offset:49152
  ds_read_b64_tr_b16 v[114:115], v21 offset:50176
  ds_read_b64_tr_b16 v[116:117], v21 offset:53248
  ds_read_b64_tr_b16 v[118:119], v21 offset:54272
  ds_read_b64_tr_b16 v[120:121], v21 offset:57344
  ds_read_b64_tr_b16 v[122:123], v21 offset:58368
  ds_read_b64_tr_b16 v[124:125], v21 offset:61440
  ds_read_b64_tr_b16 v[126:127], v21 offset:62464
  s_add_u32 s57, s54, 1376256
  buffer_load_dwordx4 v[48:51], v16, s[20:23], s57 offen
  v_mul_f32 v8, v64, v64
  v_mul_f32 v9, v65, v65
  v_fma_f32 v8, v8, v23, v12
  v_fma_f32 v9, v9, v23, v12
  v_mul_f32 v8, v8, v64
  v_mul_f32 v9, v9, v65
  v_exp_f32 v8, v8
  v_exp_f32 v9, v9
  v_fma_f32 v8, v8, v24, v24
  v_fma_f32 v9, v9, v24, v24
  v_rcp_f32 v8, v8
  v_rcp_f32 v9, v9
  v_mul_f32 v64, v64, v8
  v_mfma_f32_32x32x16_bf16 v[80:95], v[100:103], a[4:7], v[80:95]
  s_waitcnt vmcnt(7)
  ds_write_b128 v18, v[56:59] offset:16384
  s_add_u32 s57, s54, 1490944
  buffer_load_dwordx4 v[52:55], v16, s[20:23], s57 offen
  v_mul_f32 v65, v65, v9
  v_cvt_pk_bf16_f32 v64, v64, v65
  v_mul_f32 v10, v66, v66
  v_mul_f32 v11, v67, v67
  v_fma_f32 v10, v10, v23, v12
  v_fma_f32 v11, v11, v23, v12
  v_mul_f32 v10, v10, v66
  v_mul_f32 v11, v11, v67
  v_exp_f32 v10, v10
  v_exp_f32 v11, v11
  v_fma_f32 v10, v10, v24, v24
  v_fma_f32 v11, v11, v24, v24
  v_rcp_f32 v10, v10
  v_mfma_f32_32x32x16_bf16 v[80:95], v[104:107], a[8:11], v[80:95]
  s_waitcnt vmcnt(7)
  ds_write_b128 v18, v[60:63] offset:24576
  v_rcp_f32 v11, v11
  v_mul_f32 v66, v66, v10
  v_mul_f32 v67, v67, v11
  v_cvt_pk_bf16_f32 v65, v66, v67
  v_mul_f32 v8, v68, v68
  v_mul_f32 v9, v69, v69
  v_fma_f32 v8, v8, v23, v12
  v_fma_f32 v9, v9, v23, v12
  v_mul_f32 v8, v8, v68
  v_mul_f32 v9, v9, v69
  v_exp_f32 v8, v8
  v_exp_f32 v9, v9
  v_fma_f32 v8, v8, v24, v24
  v_mfma_f32_32x32x16_bf16 v[80:95], v[108:111], a[12:15], v[80:95]
  v_fma_f32 v9, v9, v24, v24
  v_rcp_f32 v8, v8
  v_rcp_f32 v9, v9
  v_mul_f32 v68, v68, v8
  v_mul_f32 v69, v69, v9
  v_cvt_pk_bf16_f32 v66, v68, v69
  v_mul_f32 v10, v70, v70
  v_mul_f32 v11, v71, v71
  v_fma_f32 v10, v10, v23, v12
  v_fma_f32 v11, v11, v23, v12
  v_mul_f32 v10, v10, v70
  v_mul_f32 v11, v11, v71
  s_waitcnt lgkmcnt(0)
  s_barrier
  v_mfma_f32_32x32x16_bf16 v[80:95], v[112:115], a[16:19], v[80:95]
  ds_read_b64_tr_b16 v[96:97], v22 offset:0
  ds_read_b64_tr_b16 v[98:99], v22 offset:1024
  ds_read_b64_tr_b16 v[100:101], v22 offset:4096
  ds_read_b64_tr_b16 v[102:103], v22 offset:5120
  ds_read_b64_tr_b16 v[104:105], v22 offset:8192
  ds_read_b64_tr_b16 v[106:107], v22 offset:9216
  ds_read_b64_tr_b16 v[108:109], v22 offset:12288
  ds_read_b64_tr_b16 v[110:111], v22 offset:13312
  s_add_u32 s57, s54, 1605632
  buffer_load_dwordx4 v[56:59], v16, s[20:23], s57 offen
  v_exp_f32 v10, v10
  v_exp_f32 v11, v11
  v_fma_f32 v10, v10, v24, v24
  v_fma_f32 v11, v11, v24, v24
  v_rcp_f32 v10, v10
  v_rcp_f32 v11, v11
  v_mul_f32 v70, v70, v10
  v_mul_f32 v71, v71, v11
  v_cvt_pk_bf16_f32 v67, v70, v71
  v_mul_f32 v8, v72, v72
  v_mul_f32 v9, v73, v73
  v_fma_f32 v8, v8, v23, v12
  v_fma_f32 v9, v9, v23, v12
  v_mfma_f32_32x32x16_bf16 v[80:95], v[116:119], a[20:23], v[80:95]
  s_waitcnt vmcnt(6)
  ds_write_b128 v17, v[32:35] offset:0
  s_add_u32 s57, s54, 1720320
  buffer_load_dwordx4 v[60:63], v16, s[20:23], s57 offen
  v_mul_f32 v8, v8, v72
  v_mul_f32 v9, v9, v73
  v_exp_f32 v8, v8
  v_exp_f32 v9, v9
  v_fma_f32 v8, v8, v24, v24
  v_fma_f32 v9, v9, v24, v24
  v_rcp_f32 v8, v8
  v_rcp_f32 v9, v9
  v_mul_f32 v72, v72, v8
  v_mul_f32 v73, v73, v9
  v_cvt_pk_bf16_f32 v68, v72, v73
  v_mul_f32 v10, v74, v74
  v_mul_f32 v11, v75, v75
  v_mfma_f32_32x32x16_bf16 v[80:95], v[120:123], a[24:27], v[80:95]
  s_waitcnt vmcnt(6)
  ds_write_b128 v17, v[36:39] offset:8192
  v_fma_f32 v10, v10, v23, v12
  v_fma_f32 v11, v11, v23, v12
  v_mul_f32 v10, v10, v74
  v_mul_f32 v11, v11, v75
  v_exp_f32 v10, v10
  v_exp_f32 v11, v11
  v_fma_f32 v10, v10, v24, v24
  v_fma_f32 v11, v11, v24, v24
  v_rcp_f32 v10, v10
  v_rcp_f32 v11, v11
  v_mul_f32 v74, v74, v10
  v_mul_f32 v75, v75, v11
  v_cvt_pk_bf16_f32 v69, v74, v75
  v_mfma_f32_32x32x16_bf16 v[80:95], v[124:127], a[28:31], v[80:95]
  v_mul_f32 v8, v76, v76
  v_mul_f32 v9, v77, v77
  v_fma_f32 v8, v8, v23, v12
  v_fma_f32 v9, v9, v23, v12
  v_mul_f32 v8, v8, v76
  v_mul_f32 v9, v9, v77
  v_exp_f32 v8, v8
  v_exp_f32 v9, v9
  v_fma_f32 v8, v8, v24, v24
  v_fma_f32 v9, v9, v24, v24
  v_rcp_f32 v8, v8
  v_rcp_f32 v9, v9
  s_waitcnt lgkmcnt(0)
  v_mfma_f32_32x32x16_bf16 v[80:95], v[96:99], a[32:35], v[80:95]
  ds_read_b64_tr_b16 v[112:113], v22 offset:16384
  ds_read_b64_tr_b16 v[114:115], v22 offset:17408
  ds_read_b64_tr_b16 v[116:117], v22 offset:20480
  ds_read_b64_tr_b16 v[118:119], v22 offset:21504
  ds_read_b64_tr_b16 v[120:121], v22 offset:24576
  ds_read_b64_tr_b16 v[122:123], v22 offset:25600
  ds_read_b64_tr_b16 v[124:125], v22 offset:28672
  ds_read_b64_tr_b16 v[126:127], v22 offset:29696
  v_mul_f32 v76, v76, v8
  v_mul_f32 v77, v77, v9
  v_cvt_pk_bf16_f32 v70, v76, v77
  v_mul_f32 v10, v78, v78
  v_mul_f32 v11, v79, v79
  v_fma_f32 v10, v10, v23, v12
  v_fma_f32 v11, v11, v23, v12
  v_mul_f32 v10, v10, v78
  v_mul_f32 v11, v11, v79
  v_exp_f32 v10, v10
  v_exp_f32 v11, v11
  v_fma_f32 v10, v10, v24, v24
  v_fma_f32 v11, v11, v24, v24
  v_mfma_f32_32x32x16_bf16 v[80:95], v[100:103], a[36:39], v[80:95]
  s_waitcnt vmcnt(5)
  ds_write_b128 v17, v[40:43] offset:16384
  v_rcp_f32 v10, v10
  v_rcp_f32 v11, v11
  v_mul_f32 v78, v78, v10
  v_mul_f32 v79, v79, v11
  v_cvt_pk_bf16_f32 v71, v78, v79
  v_mov_b32 v72, 0
  v_mov_b32 v73, 0
  v_dot2c_f32_bf16 v72, s62, v64
  v_dot2c_f32_bf16 v73, v64, v64
  v_dot2c_f32_bf16 v72, s62, v65
  v_dot2c_f32_bf16 v73, v65, v65
  v_dot2c_f32_bf16 v72, s62, v66
  v_dot2c_f32_bf16 v73, v66, v66
  v_mfma_f32_32x32x16_bf16 v[80:95], v[104:107], a[40:43], v[80:95]
  s_waitcnt vmcnt(4)
  ds_write_b128 v17, v[44:47] offset:24576
  v_dot2c_f32_bf16 v72, s62, v67
  v_dot2c_f32_bf16 v73, v67, v67
  v_dot2c_f32_bf16 v72, s62, v68
  v_dot2c_f32_bf16 v73, v68, v68
  v_dot2c_f32_bf16 v72, s62, v69
  v_dot2c_f32_bf16 v73, v69, v69
  v_dot2c_f32_bf16 v72, s62, v70
  v_dot2c_f32_bf16 v73, v70, v70
  v_dot2c_f32_bf16 v72, s62, v71
  v_dot2c_f32_bf16 v73, v71, v71
  s_nop 1
  v_mov_b32 v74, v72
  v_mov_b32 v75, v73
  s_nop 0
  v_permlane32_swap_b32 v72, v74
  v_mfma_f32_32x32x16_bf16 v[80:95], v[108:111], a[44:47], v[80:95]
  v_permlane32_swap_b32 v73, v75
  v_add_f32 v72, v72, v74
  v_add_f32 v73, v73, v75
  v_lshlrev_b32 v76, 4, v0
  s_lshl_b32 s53, s14, 1
  s_add_u32 s53, s53, s59
  s_mul_i32 s60, s53, 14336
  s_lshl_b32 s53, s15, 2
  s_add_u32 s53, s53, s58
  s_lshl_b32 s53, s53, 9
  s_add_u32 s53, s53, s60
  s_waitcnt vmcnt(8)
  s_mov_b32 s56, 0
k1_nonce:
  v_readfirstlane_b32 s96, v14
  v_readfirstlane_b32 s97, v15
  s_cmp_lg_u32 s96, 0
  s_cbranch_scc1 k1_nonce_ok
  global_load_dwordx2 v[14:15], v13, s[10:11] sc0 sc1
  s_add_u32 s56, s56, 1
  s_waitcnt vmcnt(0)
  s_cmp_lt_u32 s56, 0x200000
  s_cbranch_scc1 k1_nonce
k1_nonce_ok:
  v_mov_b32 v74, v14
  v_mov_b32 v75, v15
  s_mov_b32 exec_hi, 0
  buffer_store_dwordx4 v[72:75], v76, s[32:35], s53 offen sc0 sc1
  s_mov_b64 exec, -1
  s_waitcnt lgkmcnt(0)
  s_barrier
  v_mfma_f32_32x32x16_bf16 v[80:95], v[112:115], a[48:51], v[80:95]
  ds_read_b64_tr_b16 v[96:97], v21 offset:0
  ds_read_b64_tr_b16 v[98:99], v21 offset:1024
  ds_read_b64_tr_b16 v[100:101], v21 offset:4096
  ds_read_b64_tr_b16 v[102:103], v21 offset:5120
  ds_read_b64_tr_b16 v[104:105], v21 offset:8192
  ds_read_b64_tr_b16 v[106:107], v21 offset:9216
  ds_read_b64_tr_b16 v[108:109], v21 offset:12288
  ds_read_b64_tr_b16 v[110:111], v21 offset:13312
  v_mfma_f32_32x32x16_bf16 v[80:95], v[116:119], a[52:55], v[80:95]
  s_waitcnt vmcnt(4)
  ds_write_b128 v17, v[48:51] offset:32768
  v_mfma_f32_32x32x16_bf16 v[80:95], v[120:123], a[56:59], v[80:95]
  s_waitcnt vmcnt(3)
  ds_write_b128 v17, v[52:55] offset:40960
  v_mfma_f32_32x32x16_bf16 v[80:95], v[124:127], a[60:63], v[80:95]
  s_waitcnt lgkmcnt(0)
  v_mfma_f32_32x32x16_bf16 v[80:95], v[96:99], a[64:67], v[80:95]
  ds_read_b64_tr_b16 v[112:113], v21 offset:16384
  ds_read_b64_tr_b16 v[114:115], v21 offset:17408
  ds_read_b64_tr_b16 v[116:117], v21 offset:20480
  ds_read_b64_tr_b16 v[118:119], v21 offset:21504
  ds_read_b64_tr_b16 v[120:121], v21 offset:24576
  ds_read_b64_tr_b16 v[122:123], v21 offset:25600
  ds_read_b64_tr_b16 v[124:125], v21 offset:28672
  ds_read_b64_tr_b16 v[126:127], v21 offset:29696
  v_mfma_f32_32x32x16_bf16 v[80:95], v[100:103], a[68:71], v[80:95]
  s_waitcnt vmcnt(2)
  ds_write_b128 v17, v[56:59] offset:49152
  v_mfma_f32_32x32x16_bf16 v[80:95], v[104:107], a[72:75], v[80:95]
  s_waitcnt vmcnt(1)
  ds_write_b128 v17, v[60:63] offset:57344
  v_mfma_f32_32x32x16_bf16 v[80:95], v[108:111], a[76:79], v[80:95]
  s_waitcnt lgkmcnt(0)
  s_barrier
  v_mfma_f32_32x32x16_bf16 v[80:95], v[112:115], a[80:83], v[80:95]
  ds_read_b64_tr_b16 v[96:97], v21 offset:32768
  ds_read_b64_tr_b16 v[98:99], v21 offset:33792
  ds_read_b64_tr_b16 v[100:101], v21 offset:36864
  ds_read_b64_tr_b16 v[102:103], v21 offset:37888
  ds_read_b64_tr_b16 v[104:105], v21 offset:40960
  ds_read_b64_tr_b16 v[106:107], v21 offset:41984
  ds_read_b64_tr_b16 v[108:109], v21 offset:45056
  ds_read_b64_tr_b16 v[110:111], v21 offset:46080
  v_mfma_f32_32x32x16_bf16 v[80:95], v[116:119], a[84:87], v[80:95]
  v_mfma_f32_32x32x16_bf16 v[80:95], v[120:123], a[88:91], v[80:95]
  v_mfma_f32_32x32x16_bf16 v[80:95], v[124:127], a[92:95], v[80:95]
  v_lshlrev_b32 v76, 4, v0
  s_mul_i32 s61, s58, 3584
  s_add_u32 s61, s61, s60
  v_and_b32 v77, 31, v0
  v_lshlrev_b32 v77, 4, v77
  buffer_load_dwordx4 a[16:19], v76, s[32:35], s61 offen offset:0 sc0 sc1
  buffer_load_dwordx4 a[20:23], v76, s[32:35], s61 offen offset:1024 sc0 sc1
  buffer_load_dwordx4 a[24:27], v76, s[32:35], s61 offen offset:2048 sc0 sc1
  buffer_load_dwordx4 a[28:31], v77, s[32:35], s61 offen offset:3072 sc0 sc1
  s_waitcnt lgkmcnt(0)
  v_mfma_f32_32x32x16_bf16 v[80:95], v[96:99], a[96:99], v[80:95]
  ds_read_b64_tr_b16 v[112:113], v21 offset:49152
  ds_read_b64_tr_b16 v[114:115], v21 offset:50176
  ds_read_b64_tr_b16 v[116:117], v21 offset:53248
  ds_read_b64_tr_b16 v[118:119], v21 offset:54272
  ds_read_b64_tr_b16 v[120:121], v21 offset:57344
  ds_read_b64_tr_b16 v[122:123], v21 offset:58368
  ds_read_b64_tr_b16 v[124:125], v21 offset:61440
  ds_read_b64_tr_b16 v[126:127], v21 offset:62464
  v_and_b32 v2, 31, v0
  v_lshrrev_b32 v3, 5, v0
  v_lshlrev_b32 v2, 6, v2
  v_lshl_add_u32 v2, v3, 5, v2
  s_lshl_b32 s84, s58, 11
  s_lshl_b32 s85, s59, 14
  s_add_u32 s84, s84, s85
  v_mfma_f32_32x32x16_bf16 v[80:95], v[100:103], a[100:103], v[80:95]
  s_add_u32 s84, s84, 99328
  v_add_u32 v29, s84, v2
  v_lshrrev_b32 v3, 4, v0
  v_bfe_u32 v4, v0, 2, 2
  v_and_b32 v5, 3, v0
  v_lshl_add_u32 v3, v3, 3, v4
  v_lshlrev_b32 v3, 6, v3
  v_mfma_f32_32x32x16_bf16 v[80:95], v[104:107], a[104:107], v[80:95]
  v_lshl_add_u32 v3, v5, 3, v3
  v_add_u32 v30, s84, v3
  v_lshlrev_b32 v31, 4, v0
  s_lshl_b32 s86, s14, 1
  s_add_u32 s86, s86, s59
  s_lshl_b32 s84, s15, 3
  s_lshl_b32 s87, s58, 1
  v_mfma_f32_32x32x16_bf16 v[80:95], v[108:111], a[108:111], v[80:95]
  s_add_u32 s84, s84, s87
  s_mul_i32 s87, s84, 37
  s_lshr_b32 s87, s87, 8
  s_mul_i32 s65, s87, 7
  s_sub_u32 s84, s84, s65
  s_waitcnt lgkmcnt(0)
  v_mfma_f32_32x32x16_bf16 v[80:95], v[112:115], v[128:131], v[80:95]
  s_add_u32 s65, s84, 6
  s_sub_u32 s66, s84, 1
  s_cmp_eq_u32 s84, 0
  s_cselect_b32 s65, s65, s66
  s_bitcmp1_b32 s87, 0
  s_cselect_b32 s84, s65, s84
  s_lshl_b32 s87, s87, 6
  s_add_u32 s87, s87, s86
  s_mul_i32 s87, s87, 7
  v_mfma_f32_32x32x16_bf16 v[80:95], v[116:119], v[132:135], v[80:95]
  s_add_u32 s87, s87, s84
  s_lshl_b32 s88, s87, 10
  s_lshl_b32 s84, s15, 3
  s_lshl_b32 s87, s58, 1
  s_add_u32 s84, s84, s87
  s_add_u32 s84, s84, 1
  s_mul_i32 s87, s84, 37
  v_mfma_f32_32x32x16_bf16 v[80:95], v[120:123], v[136:139], v[80:95]
  s_lshr_b32 s87, s87, 8
  s_mul_i32 s65, s87, 7
  s_sub_u32 s84, s84, s65
  s_add_u32 s65, s84, 6
  s_sub_u32 s66, s84, 1
  s_cmp_eq_u32 s84, 0
  s_cselect_b32 s65, s65, s66
  s_bitcmp1_b32 s87, 0
  s_cselect_b32 s84, s65, s84
  v_mfma_f32_32x32x16_bf16 v[80:95], v[124:127], v[140:143], v[80:95]
  s_lshl_b32 s87, s87, 6
  s_add_u32 s87, s87, s86
  s_mul_i32 s87, s87, 7
  s_add_u32 s87, s87, s84
  s_lshl_b32 s89, s87, 10
  v_and_b32 v2, 15, v0
  v_bfe_u32 v3, v0, 4, 1
  v_lshrrev_b32 v4, 5, v0
  v_lshlrev_b32 v2, 4, v2
  v_lshl_add_u32 v2, v3, 10, v2
  v_lshl_add_u32 v2, v4, 9, v2
  s_mul_i32 s53, s14, 28
  s_lshl_b32 s56, s15, 2
  s_add_u32 s53, s53, s56
  s_add_u32 s53, s53, s58
  s_lshl_b32 s53, s53, 12
  s_lshl_b32 s56, s59, 11
  s_add_u32 s53, s53, s56
  v_mul_f32 v8, v80, v80
  v_mul_f32 v9, v81, v81
  v_fma_f32 v8, v8, v23, v12
  v_fma_f32 v9, v9, v23, v12
  v_mul_f32 v8, v8, v80
  v_mul_f32 v9, v9, v81
  v_exp_f32 v8, v8
  v_exp_f32 v9, v9
  v_fma_f32 v8, v8, v24, v24
  v_fma_f32 v9, v9, v24, v24
  v_rcp_f32 v8, v8
  v_rcp_f32 v9, v9
  v_mul_f32 v80, v80, v8
  v_mul_f32 v81, v81, v9
  v_cvt_pk_bf16_f32 v80, v80, v81
  v_mul_f32 v10, v82, v82
  v_mul_f32 v11, v83, v83
  v_fma_f32 v10, v10, v23, v12
  v_fma_f32 v11, v11, v23, v12
  v_mul_f32 v10, v10, v82
  v_mul_f32 v11, v11, v83
  v_exp_f32 v10, v10
  v_exp_f32 v11, v11
  v_fma_f32 v10, v10, v24, v24
  v_fma_f32 v11, v11, v24, v24
  v_rcp_f32 v10, v10
  v_rcp_f32 v11, v11
  v_mul_f32 v82, v82, v10
  v_mul_f32 v83, v83, v11
  v_cvt_pk_bf16_f32 v81, v82, v83
  v_mul_f32 v8, v84, v84
  v_mul_f32 v9, v85, v85
  v_fma_f32 v8, v8, v23, v12
  v_fma_f32 v9, v9, v23, v12
  v_mul_f32 v8, v8, v84
  v_mul_f32 v9, v9, v85
  v_exp_f32 v8, v8
  v_exp_f32 v9, v9
  v_fma_f32 v8, v8, v24, v24
  v_fma_f32 v9, v9, v24, v24
  v_rcp_f32 v8, v8
  v_rcp_f32 v9, v9
  v_mul_f32 v84, v84, v8
  v_mul_f32 v85, v85, v9
  v_cvt_pk_bf16_f32 v82, v84, v85
  v_mul_f32 v10, v86, v86
  v_mul_f32 v11, v87, v87
  v_fma_f32 v10, v10, v23, v12
  v_fma_f32 v11, v11, v23, v12
  v_mul_f32 v10, v10, v86
  v_mul_f32 v11, v11, v87
  v_exp_f32 v10, v10
  v_exp_f32 v11, v11
  v_fma_f32 v10, v10, v24, v24
  v_fma_f32 v11, v11, v24, v24
  v_rcp_f32 v10, v10
  v_rcp_f32 v11, v11
  v_mul_f32 v86, v86, v10
  v_mul_f32 v87, v87, v11
  v_cvt_pk_bf16_f32 v83, v86, v87
  v_mul_f32 v8, v88, v88
  v_mul_f32 v9, v89, v89
  v_fma_f32 v8, v8, v23, v12
  v_fma_f32 v9, v9, v23, v12
  v_mul_f32 v8, v8, v88
  v_mul_f32 v9, v9, v89
  v_exp_f32 v8, v8
  v_exp_f32 v9, v9
  v_fma_f32 v8, v8, v24, v24
  v_fma_f32 v9, v9, v24, v24
  v_rcp_f32 v8, v8
  v_rcp_f32 v9, v9
  v_mul_f32 v88, v88, v8
  v_mul_f32 v89, v89, v9
  v_cvt_pk_bf16_f32 v84, v88, v89
  v_mul_f32 v10, v90, v90
  v_mul_f32 v11, v91, v91
  v_fma_f32 v10, v10, v23, v12
  v_fma_f32 v11, v11, v23, v12
  v_mul_f32 v10, v10, v90
  v_mul_f32 v11, v11, v91
  v_exp_f32 v10, v10
  v_exp_f32 v11, v11
  v_fma_f32 v10, v10, v24, v24
  v_fma_f32 v11, v11, v24, v24
  v_rcp_f32 v10, v10
  v_rcp_f32 v11, v11
  v_mul_f32 v90, v90, v10
  v_mul_f32 v91, v91, v11
  v_cvt_pk_bf16_f32 v85, v90, v91
  v_mul_f32 v8, v92, v92
  v_mul_f32 v9, v93, v93
  v_fma_f32 v8, v8, v23, v12
  v_fma_f32 v9, v9, v23, v12
  v_mul_f32 v8, v8, v92
  v_mul_f32 v9, v9, v93
  v_exp_f32 v8, v8
  v_exp_f32 v9, v9
  v_fma_f32 v8, v8, v24, v24
  v_fma_f32 v9, v9, v24, v24
  v_rcp_f32 v8, v8
  v_rcp_f32 v9, v9
  v_mul_f32 v92, v92, v8
  v_mul_f32 v93, v93, v9
  v_cvt_pk_bf16_f32 v86, v92, v93
  v_mul_f32 v10, v94, v94
  v_mul_f32 v11, v95, v95
  v_fma_f32 v10, v10, v23, v12
  v_fma_f32 v11, v11, v23, v12
  v_mul_f32 v10, v10, v94
  v_mul_f32 v11, v11, v95
  v_exp_f32 v10, v10
  v_exp_f32 v11, v11
  v_fma_f32 v10, v10, v24, v24
  v_fma_f32 v11, v11, v24, v24
  v_rcp_f32 v10, v10
  v_rcp_f32 v11, v11
  v_mul_f32 v94, v94, v10
  v_mul_f32 v95, v95, v11
  v_cvt_pk_bf16_f32 v87, v94, v95
  buffer_store_dwordx4 v[80:83], v2, s[28:31], s53 offen sc1
  buffer_store_dwordx4 v[84:87], v2, s[28:31], s53 offen offset:256 sc1
  s_mov_b32 s56, 0
  s_waitcnt vmcnt(2)
k1_poll:
  v_accvgpr_read_b32 v32, a16
  v_accvgpr_read_b32 v33, a17
  v_accvgpr_read_b32 v34, a18
  v_accvgpr_read_b32 v35, a19
  v_accvgpr_read_b32 v36, a20
  v_accvgpr_read_b32 v37, a21
  v_accvgpr_read_b32 v38, a22
  v_accvgpr_read_b32 v39, a23
  v_accvgpr_read_b32 v40, a24
  v_accvgpr_read_b32 v41, a25
  v_accvgpr_read_b32 v42, a26
  v_accvgpr_read_b32 v43, a27
  v_accvgpr_read_b32 v44, a28
  v_accvgpr_read_b32 v45, a29
  v_accvgpr_read_b32 v46, a30
  v_accvgpr_read_b32 v47, a31
  v_mul_f32 v44, 0.5, v44
  v_mul_f32 v45, 0.5, v45
  v_xor_b32 v34, v34, v14
  v_xor_b32 v35, v35, v15
  v_or_b32 v34, v34, v35
  v_xor_b32 v38, v38, v14
  v_xor_b32 v39, v39, v15
  v_or_b32 v38, v38, v39
  v_xor_b32 v42, v42, v14
  v_xor_b32 v43, v43, v15
  v_or_b32 v42, v42, v43
  v_xor_b32 v46, v46, v14
  v_xor_b32 v47, v47, v15
  v_or_b32 v46, v46, v47
  v_or_b32 v34, v34, v38
  v_or_b32 v42, v42, v46
  v_or_b32 v34, v34, v42
  v_cmp_ne_u32 vcc, 0, v34
  s_add_u32 s56, s56, 1
  s_cmp_eq_u64 vcc, 0
  s_cbranch_scc1 k1_got
  buffer_load_dwordx4 a[16:19], v76, s[32:35], s61 offen offset:0 sc0 sc1
  buffer_load_dwordx4 a[20:23], v76, s[32:35], s61 offen offset:1024 sc0 sc1
  buffer_load_dwordx4 a[24:27], v76, s[32:35], s61 offen offset:2048 sc0 sc1
  buffer_load_dwordx4 a[28:31], v77, s[32:35], s61 offen offset:3072 sc0 sc1
  s_waitcnt vmcnt(0)
  s_cmp_lt_u32 s56, 0x100000
  s_cbranch_scc1 k1_poll
k1_got:
  v_add_f32 v32, v32, v36
  v_add_f32 v40, v40, v44
  v_add_f32 v96, v32, v40
  v_add_f32 v33, v33, v37
  v_add_f32 v41, v41, v45
  v_add_f32 v97, v33, v41
  v_mov_b32 v98, v96
  v_mov_b32 v99, v97
  s_nop 0
  v_permlane32_swap_b32 v96, v98
  v_permlane32_swap_b32 v97, v99
  v_add_f32 v96, v96, v98
  v_add_f32 v97, v97, v99
  v_and_b32 v22, 31, v0
  v_lshlrev_b32 v22, 3, v22
  s_lshl_b32 s53, s59, 8
  s_add_u32 s53, s53, 107520
  v_add_u32 v22, s53, v22
  s_lshl_b32 s53, s58, 9
  v_add_u32 v2, s53, v22
  ds_write_b64 v2, v[96:97]
  s_lshl_b32 s57, s2, 8
  s_add_u32 s57, s57, 28442624
  v_and_b32 v132, 31, v0
  v_lshlrev_b32 v132, 3, v132
  v_add_u32 v132, s57, v132
  s_cmp_lt_u32 s3, 4
  s_cbranch_scc1 e2_done0
e2_conv0:
  s_sub_u32 s56, s3, 4
  s_lshr_b32 s57, s56, 1
  s_lshl_b32 s61, s2, 1
  s_add_u32 s61, s61, s57
  s_mul_i32 s56, s56, 14080
  s_add_u32 s56, s56, 98304
  v_mov_b32 v112, s56
  v_mov_b32 v116, 0
  v_mov_b32 v117, 0
  ds_write_b64 v112, v[116:117] offset:14072
  v_lshlrev_b32 v114, 2, v0
  s_lshl_b32 s57, s61, 8
  v_add_u32 v114, s57, v114
  s_lshl_b32 s57, s61, 1
  v_mov_b32 v115, s57
  global_load_dword v104, v114, s[68:69]
  global_load_dword v105, v114, s[70:71]
  global_load_dword v106, v114, s[72:73]
  global_load_dword v107, v114, s[74:75]
  global_load_dword v108, v114, s[76:77]
  global_load_dword v109, v114, s[78:79]
  global_load_ushort v110, v115, s[80:81]
  global_load_ushort v111, v115, s[82:83]
e2_done0:
  v_lshlrev_b32 v32, 16, v64
  v_and_b32 v33, 0xffff0000, v64
  v_lshlrev_b32 v34, 16, v65
  v_and_b32 v35, 0xffff0000, v65
  v_lshlrev_b32 v36, 16, v66
  v_and_b32 v37, 0xffff0000, v66
  v_lshlrev_b32 v38, 16, v67
  v_and_b32 v39, 0xffff0000, v67
  v_lshlrev_b32 v40, 16, v68
  v_and_b32 v41, 0xffff0000, v68
  v_lshlrev_b32 v42, 16, v69
  v_and_b32 v43, 0xffff0000, v69
  v_lshlrev_b32 v44, 16, v70
  v_and_b32 v45, 0xffff0000, v70
  v_lshlrev_b32 v46, 16, v71
  v_and_b32 v47, 0xffff0000, v71
  s_waitcnt lgkmcnt(0)
  s_barrier
  ds_read_b64 v[96:97], v22 offset:0
  ds_read_b64 v[98:99], v22 offset:512
  ds_read_b64 v[100:101], v22 offset:1024
  ds_read_b64 v[102:103], v22 offset:1536
  s_waitcnt lgkmcnt(0)
  v_add_f32 v96, v96, v98
  v_add_f32 v100, v100, v102
  v_add_f32 v96, v96, v100
  v_add_f32 v97, v97, v99
  v_add_f32 v101, v101, v103
  v_add_f32 v97, v97, v101
  v_mul_f32 v96, 0x3a924925, v96
  v_mul_f32 v97, 0x3a924925, v97
  v_fma_f32 v97, -v96, v96, v97
  v_max_f32 v97, 0, v97
  v_cvt_pk_bf16_f32 v4, v96, v96
  v_lshlrev_b32 v96, 16, v4
  v_cvt_pk_bf16_f32 v4, v97, v97
  v_lshlrev_b32 v97, 16, v4
  v_add_f32 v97, 0x3727c5ac, v97
  v_cvt_pk_bf16_f32 v4, v97, v97
  v_lshlrev_b32 v97, 16, v4
  v_sqrt_f32 v97, v97
  s_nop 0
  v_cvt_pk_bf16_f32 v4, v97, v97
  v_lshlrev_b32 v97, 16, v4
  v_rcp_f32 v97, v97
  v_sub_f32 v32, v32, v96
  v_sub_f32 v33, v33, v96
  v_sub_f32 v34, v34, v96
  v_sub_f32 v35, v35, v96
  v_sub_f32 v36, v36, v96
  v_sub_f32 v37, v37, v96
  v_sub_f32 v38, v38, v96
  v_sub_f32 v39, v39, v96
  v_sub_f32 v40, v40, v96
  v_sub_f32 v41, v41, v96
  v_sub_f32 v42, v42, v96
  v_sub_f32 v43, v43, v96
  v_sub_f32 v44, v44, v96
  v_sub_f32 v45, v45, v96
  v_sub_f32 v46, v46, v96
  v_sub_f32 v47, v47, v96
  v_mul_f32 v32, v32, v97
  v_mul_f32 v33, v33, v97
  v_mul_f32 v34, v34, v97
  v_mul_f32 v35, v35, v97
  v_mul_f32 v36, v36, v97
  v_mul_f32 v37, v37, v97
  v_mul_f32 v38, v38, v97
  v_mul_f32 v39, v39, v97
  v_mul_f32 v40, v40, v97
  v_mul_f32 v41, v41, v97
  v_mul_f32 v42, v42, v97
  v_mul_f32 v43, v43, v97
  v_mul_f32 v44, v44, v97
  v_mul_f32 v45, v45, v97
  v_mul_f32 v46, v46, v97
  v_mul_f32 v47, v47, v97
  v_cvt_pk_bf16_f32 v64, v32, v33
  v_cvt_pk_bf16_f32 v65, v34, v35
  v_cvt_pk_bf16_f32 v66, v36, v37
  v_cvt_pk_bf16_f32 v67, v38, v39
  v_cvt_pk_bf16_f32 v68, v40, v41
  v_cvt_pk_bf16_f32 v69, v42, v43
  v_cvt_pk_bf16_f32 v70, v44, v45
  v_cvt_pk_bf16_f32 v71, v46, v47
  ds_write_b128 v29, v[64:67]
  ds_write_b128 v29, v[68:71] offset:16
  ds_read_b64_tr_b16 v[48:49], v30 offset:0
  ds_read_b64_tr_b16 v[50:51], v30 offset:256
  ds_read_b64_tr_b16 v[52:53], v30 offset:32
  ds_read_b64_tr_b16 v[54:55], v30 offset:288
  s_waitcnt lgkmcnt(2)
  buffer_store_dwordx4 v[48:51], v31, s[24:27], s88 offen sc1
  s_waitcnt lgkmcnt(0)
  buffer_store_dwordx4 v[52:55], v31, s[24:27], s89 offen sc1
  s_waitcnt vmcnt(0) lgkmcnt(0)
  s_barrier
  s_cmp_lg_u32 s3, 0
  s_cbranch_scc1 p10_ns
  s_lshl_b32 s53, s2, 3
  s_add_u32 s53, s53, 28573696
  v_lshlrev_b32 v2, 11, v0
  v_add_u32 v2, s53, v2
  v_mov_b32 v4, s96
  v_mov_b32 v5, s97
  s_mov_b32 exec_lo, 0xff
  s_mov_b32 exec_hi, 0x0
  global_store_dwordx2 v2, v[4:5], s[8:9] sc0 sc1
  s_mov_b64 exec, -1
p10_ns:
  s_cmp_ge_u32 s3, 4
  s_cbranch_scc1 s1_nw0
  s_lshl_b32 s56, s14, 18
  s_add_u32 s56, s56, 196608
  v_lshlrev_b32 v112, 7, v0
  s_lshl_b32 s57, s15, 13
  s_cmp_eq_u32 s3, 1
  s_cbranch_scc1 s1_q1
  s_mov_b32 s57, 57344
  s_cmp_lg_u32 s3, 2
  s_cbranch_scc1 s1_q2
  s_cmp_lg_u32 s15, 0
  s_cbranch_scc1 s1_q2
s1_q1:
  s_add_u32 s56, s56, s57
  buffer_load_dword v143, v112, s[36:39], s56 offen
s1_q2:
  v_lshrrev_b32 v112, 3, v0
  v_and_b32 v113, 7, v0
  v_lshrrev_b32 v114, 1, v112
  v_xor_b32 v113, v113, v114
  v_lshlrev_b32 v113, 4, v113
  v_lshl_add_u32 v113, v112, 12, v113
  v_xor_b32 v114, 64, v113
  s_and_b32 s56, s2, 7
  s_lshr_b32 s56, s56, 1
  s_lshl_b32 s56, s56, 3
  s_bfe_u32 s57, s2, 0x30003
  s_add_u32 s56, s56, s57
  s_lshl_b32 s56, s56, 18
  s_lshl_b32 s57, s3, 10
  s_add_u32 s56, s56, s57
  s_mul_i32 s57, s3, 24576
  s_add_u32 m0, s57, 0
  s_add_u32 s61, s56, 0
  buffer_load_dwordx4 v113, s[36:39], s61 offen lds
  s_add_u32 m0, s57, 1024
  s_add_u32 s61, s56, 32768
  buffer_load_dwordx4 v114, s[36:39], s61 offen lds
  s_add_u32 m0, s57, 2048
  s_add_u32 s61, s56, 65536
  buffer_load_dwordx4 v113, s[36:39], s61 offen lds
  s_add_u32 m0, s57, 3072
  s_add_u32 s61, s56, 98304
  buffer_load_dwordx4 v114, s[36:39], s61 offen lds
  s_add_u32 m0, s57, 4096
  s_add_u32 s61, s56, 131072
  buffer_load_dwordx4 v113, s[36:39], s61 offen lds
  s_add_u32 m0, s57, 5120
  s_add_u32 s61, s56, 163840
  buffer_load_dwordx4 v114, s[36:39], s61 offen lds
  s_add_u32 m0, s57, 6144
  s_add_u32 s61, s56, 196608
  buffer_load_dwordx4 v113, s[36:39], s61 offen lds
  s_add_u32 m0, s57, 7168
  s_add_u32 s61, s56, 229376
  buffer_load_dwordx4 v114, s[36:39], s61 offen lds
  s_add_u32 m0, s57, 8192
  s_add_u32 s61, s56, 128
  buffer_load_dwordx4 v113, s[36:39], s61 offen lds
  s_add_u32 m0, s57, 9216
  s_add_u32 s61, s56, 32896
  buffer_load_dwordx4 v114, s[36:39], s61 offen lds
  s_add_u32 m0, s57, 10240
  s_add_u32 s61, s56, 65664
  buffer_load_dwordx4 v113, s[36:39], s61 offen lds
  s_add_u32 m0, s57, 11264
  s_add_u32 s61, s56, 98432
  buffer_load_dwordx4 v114, s[36:39], s61 offen lds
  s_add_u32 m0, s57, 12288
  s_add_u32 s61, s56, 131200
  buffer_load_dwordx4 v113, s[36:39], s61 offen lds
  s_add_u32 m0, s57, 13312
  s_add_u32 s61, s56, 163968
  buffer_load_dwordx4 v114, s[36:39], s61 offen lds
  s_add_u32 m0, s57, 14336
  s_add_u32 s61, s56, 196736
  buffer_load_dwordx4 v113, s[36:39], s61 offen lds
  s_add_u32 m0, s57, 15360
  s_add_u32 s61, s56, 229504
  buffer_load_dwordx4 v114, s[36:39], s61 offen lds
s1_nw0:
  s_lshl_b32 s93, s14, 3
  s_add_u32 s93, s93, s15
  s_lshl_b32 s93, s93, 3
  s_add_u32 s93, s93, s3
  s_lshl_b32 s93, s93, 3
  s_add_u32 s93, s93, 28377088
  s_branch p1_done
k1_aux:
  s_load_dwordx2 s[84:85], s[0:1], 104
  s_waitcnt lgkmcnt(0)
  s_mov_b32 s20, s84
  s_and_b32 s21, s85, 0xffff
  s_mov_b32 s22, 917504
  s_mov_b32 s23, 0x00020000
  s_add_u32 s24, s8, 12582912
  s_addc_u32 s25, s9, 0
  s_and_b32 s25, s25, 0xffff
  s_mov_b32 s26, 2097152
  s_mov_b32 s27, 0x00020000
  s_add_u32 s28, s8, 25165824
  s_addc_u32 s29, s9, 0
  s_and_b32 s29, s29, 0xffff
  s_mov_b32 s30, 917504
  s_mov_b32 s31, 0x00020000
  s_mul_i32 s54, s14, 7
  s_add_u32 s54, s54, s3
  s_mul_i32 s55, s54, 1171
  s_lshr_b32 s55, s55, 15
  s_mul_i32 s56, s55, 28
  s_sub_u32 s56, s54, s56
  s_lshl_b32 s56, s56, 15
  s_lshl_b32 s55, s55, 7
  s_add_u32 s56, s56, s55
  v_lshrrev_b32 v2, 3, v0
  v_and_b32 v3, 7, v0
  v_lshlrev_b32 v3, 4, v3
  v_lshl_add_u32 v3, v2, 10, v3
  s_add_u32 s57, s56, 0
  buffer_load_dwordx4 v[112:115], v3, s[20:23], s57 offen
  s_add_u32 s57, s56, 8192
  buffer_load_dwordx4 v[116:119], v3, s[20:23], s57 offen
  s_add_u32 s57, s56, 16384
  buffer_load_dwordx4 v[120:123], v3, s[20:23], s57 offen
  s_add_u32 s57, s56, 24576
  buffer_load_dwordx4 v[124:127], v3, s[20:23], s57 offen
  s_cmp_ge_u32 s3, 2
  s_cbranch_scc1 aux_nofw
  s_and_b32 s56, s14, 15
  s_lshl_b32 s56, s56, 10
  s_mov_b32 s57, 28573696
  s_cmp_eq_u32 s3, 0
  s_cselect_b32 s57, s57, 28344320
  s_add_u32 s56, s56, s57
  v_lshlrev_b32 v30, 4, v0
  v_add_u32 v30, s56, v30
  global_load_dwordx4 v[128:131], v30, s[8:9] sc0 sc1
  s_branch aux_nofw2
aux_nofw:
  s_lshl_b32 s56, s14, 12
  v_lshlrev_b32 v30, 6, v0
  v_add_u32 v30, s56, v30
  s_cmp_lg_u32 s3, 2
  s_cbranch_scc1 aux_pw0
  global_load_dword v128, v30, s[68:69]
aux_pw0:
  s_cmp_lg_u32 s3, 3
  s_cbranch_scc1 aux_pw1
  global_load_dword v128, v30, s[70:71]
aux_pw1:
  s_cmp_lg_u32 s3, 4
  s_cbranch_scc1 aux_pw2
  global_load_dword v128, v30, s[72:73]
aux_pw2:
  s_cmp_lg_u32 s3, 5
  s_cbranch_scc1 aux_pw3
  global_load_dword v128, v30, s[74:75]
aux_pw3:
  s_cmp_lg_u32 s3, 6
  s_cbranch_scc1 aux_pw4
  global_load_dword v128, v30, s[76:77]
aux_pw4:
  s_cmp_lg_u32 s3, 7
  s_cbranch_scc1 aux_pw5
  global_load_dword v128, v30, s[78:79]
aux_pw5:
aux_nofw2:
  v_lshlrev_b32 v30, 7, v0
  s_lshl_b32 s56, s14, 18
  s_lshl_b32 s57, s3, 13
  s_add_u32 s56, s56, s57
  buffer_load_dword v31, v30, s[36:39], s56 offen
  s_add_u32 s56, s56, 65536
  buffer_load_dword v31, v30, s[36:39], s56 offen
  s_add_u32 s56, s56, 65536
  s_waitcnt vmcnt(6)
  v_mov_b32 v2, 0
  v_mov_b32 v3, 0
  v_mov_b32 v4, 0
  v_mov_b32 v5, 0
  v_dot2c_f32_bf16 v2, s62, v32
  v_dot2c_f32_bf16 v3, v32, v32
  v_dot2c_f32_bf16 v4, s62, v33
  v_dot2c_f32_bf16 v5, v33, v33
  v_dot2c_f32_bf16 v2, s62, v34
  v_dot2c_f32_bf16 v3, v34, v34
  v_dot2c_f32_bf16 v4, s62, v35
  v_dot2c_f32_bf16 v5, v35, v35
  v_dot2c_f32_bf16 v2, s62, v36
  v_dot2c_f32_bf16 v3, v36, v36
  v_dot2c_f32_bf16 v4, s62, v37
  v_dot2c_f32_bf16 v5, v37, v37
  v_dot2c_f32_bf16 v2, s62, v38
  v_dot2c_f32_bf16 v3, v38, v38
  v_dot2c_f32_bf16 v4, s62, v39
  v_dot2c_f32_bf16 v5, v39, v39
  v_dot2c_f32_bf16 v2, s62, v40
  v_dot2c_f32_bf16 v3, v40, v40
  v_dot2c_f32_bf16 v4, s62, v41
  v_dot2c_f32_bf16 v5, v41, v41
  v_dot2c_f32_bf16 v2, s62, v42
  v_dot2c_f32_bf16 v3, v42, v42
  v_dot2c_f32_bf16 v4, s62, v43
  v_dot2c_f32_bf16 v5, v43, v43
  v_dot2c_f32_bf16 v2, s62, v44
  v_dot2c_f32_bf16 v3, v44, v44
  v_dot2c_f32_bf16 v4, s62, v45
  v_dot2c_f32_bf16 v5, v45, v45
  v_dot2c_f32_bf16 v2, s62, v46
  v_dot2c_f32_bf16 v3, v46, v46
  v_dot2c_f32_bf16 v4, s62, v47
  v_dot2c_f32_bf16 v5, v47, v47
  v_dot2c_f32_bf16 v2, s62, v48
  v_dot2c_f32_bf16 v3, v48, v48
  v_dot2c_f32_bf16 v4, s62, v49
  v_dot2c_f32_bf16 v5, v49, v49
  v_dot2c_f32_bf16 v2, s62, v50
  v_dot2c_f32_bf16 v3, v50, v50
  v_dot2c_f32_bf16 v4, s62, v51
  v_dot2c_f32_bf16 v5, v51, v51
  v_dot2c_f32_bf16 v2, s62, v52
  v_dot2c_f32_bf16 v3, v52, v52
  v_dot2c_f32_bf16 v4, s62, v53
  v_dot2c_f32_bf16 v5, v53, v53
  v_dot2c_f32_bf16 v2, s62, v54
  v_dot2c_f32_bf16 v3, v54, v54
  v_dot2c_f32_bf16 v4, s62, v55
  v_dot2c_f32_bf16 v5, v55, v55
  v_dot2c_f32_bf16 v2, s62, v56
  v_dot2c_f32_bf16 v3, v56, v56
  v_dot2c_f32_bf16 v4, s62, v57
  v_dot2c_f32_bf16 v5, v57, v57
  v_dot2c_f32_bf16 v2, s62, v58
  v_dot2c_f32_bf16 v3, v58, v58
  v_dot2c_f32_bf16 v4, s62, v59
  v_dot2c_f32_bf16 v5, v59, v59
  v_dot2c_f32_bf16 v2, s62, v60
  v_dot2c_f32_bf16 v3, v60, v60
  v_dot2c_f32_bf16 v4, s62, v61
  v_dot2c_f32_bf16 v5, v61, v61
  v_dot2c_f32_bf16 v2, s62, v62
  v_dot2c_f32_bf16 v3, v62, v62
  v_dot2c_f32_bf16 v4, s62, v63
  v_dot2c_f32_bf16 v5, v63, v63
  s_nop 1
  v_add_f32 v2, v2, v4
  v_add_f32 v3, v3, v5
  s_nop 0
  v_add_f32_dpp v2, v2, v2 quad_perm:[1,0,3,2] row_mask:0xf bank_mask:0xf
  v_add_f32_dpp v3, v3, v3 quad_perm:[1,0,3,2] row_mask:0xf bank_mask:0xf
  s_nop 0
  v_add_f32_dpp v2, v2, v2 quad_perm:[2,3,0,1] row_mask:0xf bank_mask:0xf
  v_add_f32_dpp v3, v3, v3 quad_perm:[2,3,0,1] row_mask:0xf bank_mask:0xf
  s_nop 0
  v_add_f32_dpp v2, v2, v2 row_half_mirror row_mask:0xf bank_mask:0xf
  v_add_f32_dpp v3, v3, v3 row_half_mirror row_mask:0xf bank_mask:0xf
  v_mul_f32 v2, 0x3b000000, v2
  v_mul_f32 v3, 0x3b000000, v3
  v_fma_f32 v3, -v2, v2, v3
  v_max_f32 v3, 0, v3
  v_cvt_pk_bf16_f32 v4, v2, v2
  v_lshlrev_b32 v2, 16, v4
  v_cvt_pk_bf16_f32 v4, v3, v3
  v_lshlrev_b32 v3, 16, v4
  v_add_f32 v3, 0x3727c5ac, v3
  v_cvt_pk_bf16_f32 v4, v3, v3
  v_lshlrev_b32 v3, 16, v4
  v_sqrt_f32 v3, v3
  s_nop 0
  v_cvt_pk_bf16_f32 v4, v3, v3
  v_lshlrev_b32 v3, 16, v4
  v_rcp_f32 v3, v3
  v_lshlrev_b32 v6, 16, v32
  v_and_b32 v7, 0xffff0000, v32
  v_sub_f32 v6, v6, v2
  v_sub_f32 v7, v7, v2
  v_cvt_pk_bf16_f32 v32, v6, v7
  v_lshlrev_b32 v6, 16, v32
  v_and_b32 v7, 0xffff0000, v32
  v_mul_f32 v6, v6, v3
  v_mul_f32 v7, v7, v3
  v_cvt_pk_bf16_f32 v32, v6, v7
  v_lshlrev_b32 v8, 16, v33
  v_and_b32 v9, 0xffff0000, v33
  v_sub_f32 v8, v8, v2
  v_sub_f32 v9, v9, v2
  v_cvt_pk_bf16_f32 v33, v8, v9
  v_lshlrev_b32 v8, 16, v33
  v_and_b32 v9, 0xffff0000, v33
  v_mul_f32 v8, v8, v3
  v_mul_f32 v9, v9, v3
  v_cvt_pk_bf16_f32 v33, v8, v9
  v_lshlrev_b32 v6, 16, v34
  v_and_b32 v7, 0xffff0000, v34
  v_sub_f32 v6, v6, v2
  v_sub_f32 v7, v7, v2
  v_cvt_pk_bf16_f32 v34, v6, v7
  v_lshlrev_b32 v6, 16, v34
  v_and_b32 v7, 0xffff0000, v34
  v_mul_f32 v6, v6, v3
  v_mul_f32 v7, v7, v3
  v_cvt_pk_bf16_f32 v34, v6, v7
  v_lshlrev_b32 v8, 16, v35
  v_and_b32 v9, 0xffff0000, v35
  v_sub_f32 v8, v8, v2
  v_sub_f32 v9, v9, v2
  v_cvt_pk_bf16_f32 v35, v8, v9
  v_lshlrev_b32 v8, 16, v35
  v_and_b32 v9, 0xffff0000, v35
  v_mul_f32 v8, v8, v3
  v_mul_f32 v9, v9, v3
  v_cvt_pk_bf16_f32 v35, v8, v9
  v_lshlrev_b32 v6, 16, v36
  v_and_b32 v7, 0xffff0000, v36
  v_sub_f32 v6, v6, v2
  v_sub_f32 v7, v7, v2
  v_cvt_pk_bf16_f32 v36, v6, v7
  v_lshlrev_b32 v6, 16, v36
  v_and_b32 v7, 0xffff0000, v36
  v_mul_f32 v6, v6, v3
  v_mul_f32 v7, v7, v3
  v_cvt_pk_bf16_f32 v36, v6, v7
  v_lshlrev_b32 v8, 16, v37
  v_and_b32 v9, 0xffff0000, v37
  v_sub_f32 v8, v8, v2
  v_sub_f32 v9, v9, v2
  v_cvt_pk_bf16_f32 v37, v8, v9
  v_lshlrev_b32 v8, 16, v37
  v_and_b32 v9, 0xffff0000, v37
  v_mul_f32 v8, v8, v3
  v_mul_f32 v9, v9, v3
  v_cvt_pk_bf16_f32 v37, v8, v9
  v_lshlrev_b32 v6, 16, v38
  v_and_b32 v7, 0xffff0000, v38
  v_sub_f32 v6, v6, v2
  v_sub_f32 v7, v7, v2
  v_cvt_pk_bf16_f32 v38, v6, v7
  v_lshlrev_b32 v6, 16, v38
  v_and_b32 v7, 0xffff0000, v38
  v_mul_f32 v6, v6, v3
  v_mul_f32 v7, v7, v3
  v_cvt_pk_bf16_f32 v38, v6, v7
  v_lshlrev_b32 v8, 16, v39
  v_and_b32 v9, 0xffff0000, v39
  v_sub_f32 v8, v8, v2
  v_sub_f32 v9, v9, v2
  v_cvt_pk_bf16_f32 v39, v8, v9
  v_lshlrev_b32 v8, 16, v39
  v_and_b32 v9, 0xffff0000, v39
  v_mul_f32 v8, v8, v3
  v_mul_f32 v9, v9, v3
  v_cvt_pk_bf16_f32 v39, v8, v9
  v_lshlrev_b32 v6, 16, v40
  v_and_b32 v7, 0xffff0000, v40
  v_sub_f32 v6, v6, v2
  v_sub_f32 v7, v7, v2
  v_cvt_pk_bf16_f32 v40, v6, v7
  v_lshlrev_b32 v6, 16, v40
  v_and_b32 v7, 0xffff0000, v40
  v_mul_f32 v6, v6, v3
  v_mul_f32 v7, v7, v3
  v_cvt_pk_bf16_f32 v40, v6, v7
  v_lshlrev_b32 v8, 16, v41
  v_and_b32 v9, 0xffff0000, v41
  v_sub_f32 v8, v8, v2
  v_sub_f32 v9, v9, v2
  v_cvt_pk_bf16_f32 v41, v8, v9
  v_lshlrev_b32 v8, 16, v41
  v_and_b32 v9, 0xffff0000, v41
  v_mul_f32 v8, v8, v3
  v_mul_f32 v9, v9, v3
  v_cvt_pk_bf16_f32 v41, v8, v9
  v_lshlrev_b32 v6, 16, v42
  v_and_b32 v7, 0xffff0000, v42
  v_sub_f32 v6, v6, v2
  v_sub_f32 v7, v7, v2
  v_cvt_pk_bf16_f32 v42, v6, v7
  v_lshlrev_b32 v6, 16, v42
  v_and_b32 v7, 0xffff0000, v42
  v_mul_f32 v6, v6, v3
  v_mul_f32 v7, v7, v3
  v_cvt_pk_bf16_f32 v42, v6, v7
  v_lshlrev_b32 v8, 16, v43
  v_and_b32 v9, 0xffff0000, v43
  v_sub_f32 v8, v8, v2
  v_sub_f32 v9, v9, v2
  v_cvt_pk_bf16_f32 v43, v8, v9
  v_lshlrev_b32 v8, 16, v43
  v_and_b32 v9, 0xffff0000, v43
  v_mul_f32 v8, v8, v3
  v_mul_f32 v9, v9, v3
  v_cvt_pk_bf16_f32 v43, v8, v9
  v_lshlrev_b32 v6, 16, v44
  v_and_b32 v7, 0xffff0000, v44
  v_sub_f32 v6, v6, v2
  v_sub_f32 v7, v7, v2
  v_cvt_pk_bf16_f32 v44, v6, v7
  v_lshlrev_b32 v6, 16, v44
  v_and_b32 v7, 0xffff0000, v44
  v_mul_f32 v6, v6, v3
  v_mul_f32 v7, v7, v3
  v_cvt_pk_bf16_f32 v44, v6, v7
  v_lshlrev_b32 v8, 16, v45
  v_and_b32 v9, 0xffff0000, v45
  v_sub_f32 v8, v8, v2
  v_sub_f32 v9, v9, v2
  v_cvt_pk_bf16_f32 v45, v8, v9
  v_lshlrev_b32 v8, 16, v45
  v_and_b32 v9, 0xffff0000, v45
  v_mul_f32 v8, v8, v3
  v_mul_f32 v9, v9, v3
  v_cvt_pk_bf16_f32 v45, v8, v9
  v_lshlrev_b32 v6, 16, v46
  v_and_b32 v7, 0xffff0000, v46
  v_sub_f32 v6, v6, v2
  v_sub_f32 v7, v7, v2
  v_cvt_pk_bf16_f32 v46, v6, v7
  v_lshlrev_b32 v6, 16, v46
  v_and_b32 v7, 0xffff0000, v46
  v_mul_f32 v6, v6, v3
  v_mul_f32 v7, v7, v3
  v_cvt_pk_bf16_f32 v46, v6, v7
  v_lshlrev_b32 v8, 16, v47
  v_and_b32 v9, 0xffff0000, v47
  v_sub_f32 v8, v8, v2
  v_sub_f32 v9, v9, v2
  v_cvt_pk_bf16_f32 v47, v8, v9
  v_lshlrev_b32 v8, 16, v47
  v_and_b32 v9, 0xffff0000, v47
  v_mul_f32 v8, v8, v3
  v_mul_f32 v9, v9, v3
  v_cvt_pk_bf16_f32 v47, v8, v9
  v_lshlrev_b32 v6, 16, v48
  v_and_b32 v7, 0xffff0000, v48
  v_sub_f32 v6, v6, v2
  v_sub_f32 v7, v7, v2
  v_cvt_pk_bf16_f32 v48, v6, v7
  v_lshlrev_b32 v6, 16, v48
  v_and_b32 v7, 0xffff0000, v48
  v_mul_f32 v6, v6, v3
  v_mul_f32 v7, v7, v3
  v_cvt_pk_bf16_f32 v48, v6, v7
  v_lshlrev_b32 v8, 16, v49
  v_and_b32 v9, 0xffff0000, v49
  v_sub_f32 v8, v8, v2
  v_sub_f32 v9, v9, v2
  v_cvt_pk_bf16_f32 v49, v8, v9
  v_lshlrev_b32 v8, 16, v49
  v_and_b32 v9, 0xffff0000, v49
  v_mul_f32 v8, v8, v3
  v_mul_f32 v9, v9, v3
  v_cvt_pk_bf16_f32 v49, v8, v9
  v_lshlrev_b32 v6, 16, v50
  v_and_b32 v7, 0xffff0000, v50
  v_sub_f32 v6, v6, v2
  v_sub_f32 v7, v7, v2
  v_cvt_pk_bf16_f32 v50, v6, v7
  v_lshlrev_b32 v6, 16, v50
  v_and_b32 v7, 0xffff0000, v50
  v_mul_f32 v6, v6, v3
  v_mul_f32 v7, v7, v3
  v_cvt_pk_bf16_f32 v50, v6, v7
  v_lshlrev_b32 v8, 16, v51
  v_and_b32 v9, 0xffff0000, v51
  v_sub_f32 v8, v8, v2
  v_sub_f32 v9, v9, v2
  v_cvt_pk_bf16_f32 v51, v8, v9
  v_lshlrev_b32 v8, 16, v51
  v_and_b32 v9, 0xffff0000, v51
  v_mul_f32 v8, v8, v3
  v_mul_f32 v9, v9, v3
  v_cvt_pk_bf16_f32 v51, v8, v9
  v_lshlrev_b32 v6, 16, v52
  v_and_b32 v7, 0xffff0000, v52
  v_sub_f32 v6, v6, v2
  v_sub_f32 v7, v7, v2
  v_cvt_pk_bf16_f32 v52, v6, v7
  v_lshlrev_b32 v6, 16, v52
  v_and_b32 v7, 0xffff0000, v52
  v_mul_f32 v6, v6, v3
  v_mul_f32 v7, v7, v3
  v_cvt_pk_bf16_f32 v52, v6, v7
  v_lshlrev_b32 v8, 16, v53
  v_and_b32 v9, 0xffff0000, v53
  v_sub_f32 v8, v8, v2
  v_sub_f32 v9, v9, v2
  v_cvt_pk_bf16_f32 v53, v8, v9
  v_lshlrev_b32 v8, 16, v53
  v_and_b32 v9, 0xffff0000, v53
  v_mul_f32 v8, v8, v3
  v_mul_f32 v9, v9, v3
  v_cvt_pk_bf16_f32 v53, v8, v9
  v_lshlrev_b32 v6, 16, v54
  v_and_b32 v7, 0xffff0000, v54
  v_sub_f32 v6, v6, v2
  v_sub_f32 v7, v7, v2
  v_cvt_pk_bf16_f32 v54, v6, v7
  v_lshlrev_b32 v6, 16, v54
  v_and_b32 v7, 0xffff0000, v54
  v_mul_f32 v6, v6, v3
  v_mul_f32 v7, v7, v3
  v_cvt_pk_bf16_f32 v54, v6, v7
  v_lshlrev_b32 v8, 16, v55
  v_and_b32 v9, 0xffff0000, v55
  v_sub_f32 v8, v8, v2
  v_sub_f32 v9, v9, v2
  v_cvt_pk_bf16_f32 v55, v8, v9
  v_lshlrev_b32 v8, 16, v55
  v_and_b32 v9, 0xffff0000, v55
  v_mul_f32 v8, v8, v3
  v_mul_f32 v9, v9, v3
  v_cvt_pk_bf16_f32 v55, v8, v9
  v_lshlrev_b32 v6, 16, v56
  v_and_b32 v7, 0xffff0000, v56
  v_sub_f32 v6, v6, v2
  v_sub_f32 v7, v7, v2
  v_cvt_pk_bf16_f32 v56, v6, v7
  v_lshlrev_b32 v6, 16, v56
  v_and_b32 v7, 0xffff0000, v56
  v_mul_f32 v6, v6, v3
  v_mul_f32 v7, v7, v3
  v_cvt_pk_bf16_f32 v56, v6, v7
  v_lshlrev_b32 v8, 16, v57
  v_and_b32 v9, 0xffff0000, v57
  v_sub_f32 v8, v8, v2
  v_sub_f32 v9, v9, v2
  v_cvt_pk_bf16_f32 v57, v8, v9
  v_lshlrev_b32 v8, 16, v57
  v_and_b32 v9, 0xffff0000, v57
  v_mul_f32 v8, v8, v3
  v_mul_f32 v9, v9, v3
  v_cvt_pk_bf16_f32 v57, v8, v9
  v_lshlrev_b32 v6, 16, v58
  v_and_b32 v7, 0xffff0000, v58
  v_sub_f32 v6, v6, v2
  v_sub_f32 v7, v7, v2
  v_cvt_pk_bf16_f32 v58, v6, v7
  v_lshlrev_b32 v6, 16, v58
  v_and_b32 v7, 0xffff0000, v58
  v_mul_f32 v6, v6, v3
  v_mul_f32 v7, v7, v3
  v_cvt_pk_bf16_f32 v58, v6, v7
  v_lshlrev_b32 v8, 16, v59
  v_and_b32 v9, 0xffff0000, v59
  v_sub_f32 v8, v8, v2
  v_sub_f32 v9, v9, v2
  v_cvt_pk_bf16_f32 v59, v8, v9
  v_lshlrev_b32 v8, 16, v59
  v_and_b32 v9, 0xffff0000, v59
  v_mul_f32 v8, v8, v3
  v_mul_f32 v9, v9, v3
  v_cvt_pk_bf16_f32 v59, v8, v9
  v_lshlrev_b32 v6, 16, v60
  v_and_b32 v7, 0xffff0000, v60
  v_sub_f32 v6, v6, v2
  v_sub_f32 v7, v7, v2
  v_cvt_pk_bf16_f32 v60, v6, v7
  v_lshlrev_b32 v6, 16, v60
  v_and_b32 v7, 0xffff0000, v60
  v_mul_f32 v6, v6, v3
  v_mul_f32 v7, v7, v3
  v_cvt_pk_bf16_f32 v60, v6, v7
  v_lshlrev_b32 v8, 16, v61
  v_and_b32 v9, 0xffff0000, v61
  v_sub_f32 v8, v8, v2
  v_sub_f32 v9, v9, v2
  v_cvt_pk_bf16_f32 v61, v8, v9
  v_lshlrev_b32 v8, 16, v61
  v_and_b32 v9, 0xffff0000, v61
  v_mul_f32 v8, v8, v3
  v_mul_f32 v9, v9, v3
  v_cvt_pk_bf16_f32 v61, v8, v9
  v_lshlrev_b32 v6, 16, v62
  v_and_b32 v7, 0xffff0000, v62
  v_sub_f32 v6, v6, v2
  v_sub_f32 v7, v7, v2
  v_cvt_pk_bf16_f32 v62, v6, v7
  v_lshlrev_b32 v6, 16, v62
  v_and_b32 v7, 0xffff0000, v62
  v_mul_f32 v6, v6, v3
  v_mul_f32 v7, v7, v3
  v_cvt_pk_bf16_f32 v62, v6, v7
  v_lshlrev_b32 v8, 16, v63
  v_and_b32 v9, 0xffff0000, v63
  v_sub_f32 v8, v8, v2
  v_sub_f32 v9, v9, v2
  v_cvt_pk_bf16_f32 v63, v8, v9
  v_lshlrev_b32 v8, 16, v63
  v_and_b32 v9, 0xffff0000, v63
  v_mul_f32 v8, v8, v3
  v_mul_f32 v9, v9, v3
  v_cvt_pk_bf16_f32 v63, v8, v9
  v_lshlrev_b32 v6, 16, v32
  v_and_b32 v7, 0xffff0000, v32
  v_cvt_pk_f16_f32 v32, v6, v7
  v_lshlrev_b32 v8, 16, v33
  v_and_b32 v9, 0xffff0000, v33
  v_cvt_pk_f16_f32 v33, v8, v9
  v_lshlrev_b32 v6, 16, v34
  v_and_b32 v7, 0xffff0000, v34
  v_cvt_pk_f16_f32 v34, v6, v7
  v_lshlrev_b32 v8, 16, v35
  v_and_b32 v9, 0xffff0000, v35
  v_cvt_pk_f16_f32 v35, v8, v9
  v_lshlrev_b32 v6, 16, v36
  v_and_b32 v7, 0xffff0000, v36
  v_cvt_pk_f16_f32 v36, v6, v7
  v_lshlrev_b32 v8, 16, v37
  v_and_b32 v9, 0xffff0000, v37
  v_cvt_pk_f16_f32 v37, v8, v9
  v_lshlrev_b32 v6, 16, v38
  v_and_b32 v7, 0xffff0000, v38
  v_cvt_pk_f16_f32 v38, v6, v7
  v_lshlrev_b32 v8, 16, v39
  v_and_b32 v9, 0xffff0000, v39
  v_cvt_pk_f16_f32 v39, v8, v9
  v_lshlrev_b32 v6, 16, v40
  v_and_b32 v7, 0xffff0000, v40
  v_cvt_pk_f16_f32 v40, v6, v7
  v_lshlrev_b32 v8, 16, v41
  v_and_b32 v9, 0xffff0000, v41
  v_cvt_pk_f16_f32 v41, v8, v9
  v_lshlrev_b32 v6, 16, v42
  v_and_b32 v7, 0xffff0000, v42
  v_cvt_pk_f16_f32 v42, v6, v7
  v_lshlrev_b32 v8, 16, v43
  v_and_b32 v9, 0xffff0000, v43
  v_cvt_pk_f16_f32 v43, v8, v9
  v_lshlrev_b32 v6, 16, v44
  v_and_b32 v7, 0xffff0000, v44
  v_cvt_pk_f16_f32 v44, v6, v7
  v_lshlrev_b32 v8, 16, v45
  v_and_b32 v9, 0xffff0000, v45
  v_cvt_pk_f16_f32 v45, v8, v9
  v_lshlrev_b32 v6, 16, v46
  v_and_b32 v7, 0xffff0000, v46
  v_cvt_pk_f16_f32 v46, v6, v7
  v_lshlrev_b32 v8, 16, v47
  v_and_b32 v9, 0xffff0000, v47
  v_cvt_pk_f16_f32 v47, v8, v9
  v_lshlrev_b32 v6, 16, v48
  v_and_b32 v7, 0xffff0000, v48
  v_cvt_pk_f16_f32 v48, v6, v7
  v_lshlrev_b32 v8, 16, v49
  v_and_b32 v9, 0xffff0000, v49
  v_cvt_pk_f16_f32 v49, v8, v9
  v_lshlrev_b32 v6, 16, v50
  v_and_b32 v7, 0xffff0000, v50
  v_cvt_pk_f16_f32 v50, v6, v7
  v_lshlrev_b32 v8, 16, v51
  v_and_b32 v9, 0xffff0000, v51
  v_cvt_pk_f16_f32 v51, v8, v9
  v_lshlrev_b32 v6, 16, v52
  v_and_b32 v7, 0xffff0000, v52
  v_cvt_pk_f16_f32 v52, v6, v7
  v_lshlrev_b32 v8, 16, v53
  v_and_b32 v9, 0xffff0000, v53
  v_cvt_pk_f16_f32 v53, v8, v9
  v_lshlrev_b32 v6, 16, v54
  v_and_b32 v7, 0xffff0000, v54
  v_cvt_pk_f16_f32 v54, v6, v7
  v_lshlrev_b32 v8, 16, v55
  v_and_b32 v9, 0xffff0000, v55
  v_cvt_pk_f16_f32 v55, v8, v9
  v_lshlrev_b32 v6, 16, v56
  v_and_b32 v7, 0xffff0000, v56
  v_cvt_pk_f16_f32 v56, v6, v7
  v_lshlrev_b32 v8, 16, v57
  v_and_b32 v9, 0xffff0000, v57
  v_cvt_pk_f16_f32 v57, v8, v9
  v_lshlrev_b32 v6, 16, v58
  v_and_b32 v7, 0xffff0000, v58
  v_cvt_pk_f16_f32 v58, v6, v7
  v_lshlrev_b32 v8, 16, v59
  v_and_b32 v9, 0xffff0000, v59
  v_cvt_pk_f16_f32 v59, v8, v9
  v_lshlrev_b32 v6, 16, v60
  v_and_b32 v7, 0xffff0000, v60
  v_cvt_pk_f16_f32 v60, v6, v7
  v_lshlrev_b32 v8, 16, v61
  v_and_b32 v9, 0xffff0000, v61
  v_cvt_pk_f16_f32 v61, v8, v9
  v_lshlrev_b32 v6, 16, v62
  v_and_b32 v7, 0xffff0000, v62
  v_cvt_pk_f16_f32 v62, v6, v7
  v_lshlrev_b32 v8, 16, v63
  v_and_b32 v9, 0xffff0000, v63
  v_cvt_pk_f16_f32 v63, v8, v9
  ds_write_b128 v23, v[32:35] offset:0
  ds_write_b128 v24, v[36:39] offset:0
  ds_write_b128 v23, v[40:43] offset:256
  ds_write_b128 v24, v[44:47] offset:256
  ds_write_b128 v23, v[48:51] offset:512
  ds_write_b128 v24, v[52:55] offset:512
  ds_write_b128 v23, v[56:59] offset:768
  ds_write_b128 v24, v[60:63] offset:768
  v_lshlrev_b32 v2, 4, v0
  s_lshl_b32 s53, s3, 12
  v_add_u32 v2, s53, v2
  s_waitcnt vmcnt(2)
  ds_write_b128 v2, v[112:115] offset:0
  ds_write_b128 v2, v[116:119] offset:1024
  ds_write_b128 v2, v[120:123] offset:2048
  ds_write_b128 v2, v[124:127] offset:3072
  v_lshrrev_b32 v3, 2, v0
  v_and_b32 v4, 3, v0
  v_lshlrev_b32 v3, 7, v3
  v_lshl_add_u32 v3, v4, 4, v3
  v_add_u32 v3, s53, v3
  s_waitcnt lgkmcnt(0)
  ds_read_b64_tr_b16 v[112:113], v3 offset:0
  ds_read_b64_tr_b16 v[114:115], v3 offset:2048
  ds_read_b64_tr_b16 v[116:117], v3 offset:8
  ds_read_b64_tr_b16 v[118:119], v3 offset:2056
  ds_read_b64_tr_b16 v[120:121], v3 offset:64
  ds_read_b64_tr_b16 v[122:123], v3 offset:2112
  ds_read_b64_tr_b16 v[124:125], v3 offset:72
  ds_read_b64_tr_b16 v[126:127], v3 offset:2120
  v_lshlrev_b32 v2, 4, v0
  s_lshl_b32 s53, s54, 12
  s_waitcnt lgkmcnt(0)
  s_cmp_eq_u32 s3, 7
  s_cbranch_scc1 aux_nowo
  buffer_store_dwordx4 v[112:115], v2, s[28:31], s53 offen offset:0 sc1
  buffer_store_dwordx4 v[116:119], v2, s[28:31], s53 offen offset:1024 sc1
  buffer_store_dwordx4 v[120:123], v2, s[28:31], s53 offen offset:2048 sc1
  buffer_store_dwordx4 v[124:127], v2, s[28:31], s53 offen offset:3072 sc1
aux_nowo:
  s_add_u32 s32, s8, 8388608
  s_addc_u32 s33, s9, 0
  s_and_b32 s33, s33, 0xffff
  s_mov_b32 s34, 4194304
  s_mov_b32 s35, 0x00020000
  s_lshr_b32 s53, s3, 1
  s_mul_i32 s53, s53, 7
  s_mul_i32 s55, s14, 28
  s_add_u32 s53, s53, s55
  s_add_u32 s53, s53, 3
  s_lshl_b32 s53, s53, 12
  s_and_b32 s55, s3, 1
  s_lshl_b32 s55, s55, 11
  s_add_u32 s53, s53, s55
  buffer_store_dwordx4 v[112:115], v2, s[32:35], s53 offen offset:0 sc1
  buffer_store_dwordx4 v[112:115], v2, s[32:35], s53 offen offset:1024 sc1
  s_barrier
  v_lshrrev_b32 v2, 4, v0
  v_bfe_u32 v3, v0, 2, 2
  v_and_b32 v4, 3, v0
  v_lshlrev_b32 v2, 3, v2
  v_add_u32 v2, 7, v2
  v_sub_u32 v2, v2, v3
  v_lshrrev_b32 v5, 1, v4
  v_and_b32 v4, 1, v4
  s_and_b32 s53, s3, 1
  s_lshl_b32 s53, s53, 7
  s_lshr_b32 s55, s3, 1
  s_lshl_b32 s55, s55, 8
  s_add_u32 s55, s55, 98304
  v_and_b32 v6, 15, v2
  v_xor_b32 v6, v6, v5
  v_lshlrev_b32 v6, 4, v6
  v_xor_b32 v6, s53, v6
  v_lshl_add_u32 v6, v4, 3, v6
  v_lshl_add_u32 v6, v2, 10, v6
  v_add_u32 v7, s55, v6
  v_subrev_u32 v2, 4, v2
  v_and_b32 v6, 15, v2
  v_xor_b32 v6, v6, v5
  v_lshlrev_b32 v6, 4, v6
  v_xor_b32 v6, s53, v6
  v_lshl_add_u32 v6, v4, 3, v6
  v_lshl_add_u32 v6, v2, 10, v6
  v_add_u32 v8, s55, v6
  v_and_b32 v2, 15, v0
  v_lshrrev_b32 v3, 4, v0
  v_lshlrev_b32 v2, 12, v2
  v_lshl_add_u32 v2, v3, 4, v2
  s_lshl_b32 s53, s3, 18
  s_lshl_b32 s55, s14, 7
  s_add_u32 s53, s53, s55
  v_xor_b32 v9, 0, v7
  v_xor_b32 v10, 0, v8
  ds_read_b64_tr_b16 v[32:33], v9 offset:0
  ds_read_b64_tr_b16 v[34:35], v10 offset:0
  ds_read_b64_tr_b16 v[36:37], v9 offset:32768
  ds_read_b64_tr_b16 v[38:39], v10 offset:32768
  v_xor_b32 v9, 32, v7
  v_xor_b32 v10, 32, v8
  ds_read_b64_tr_b16 v[40:41], v9 offset:0
  ds_read_b64_tr_b16 v[42:43], v10 offset:0
  ds_read_b64_tr_b16 v[44:45], v9 offset:32768
  ds_read_b64_tr_b16 v[46:47], v10 offset:32768
  v_xor_b32 v9, 64, v7
  v_xor_b32 v10, 64, v8
  ds_read_b64_tr_b16 v[48:49], v9 offset:0
  ds_read_b64_tr_b16 v[50:51], v10 offset:0
  ds_read_b64_tr_b16 v[52:53], v9 offset:32768
  ds_read_b64_tr_b16 v[54:55], v10 offset:32768
  v_xor_b32 v9, 96, v7
  v_xor_b32 v10, 96, v8
  ds_read_b64_tr_b16 v[56:57], v9 offset:0
  ds_read_b64_tr_b16 v[58:59], v10 offset:0
  ds_read_b64_tr_b16 v[60:61], v9 offset:32768
  ds_read_b64_tr_b16 v[62:63], v10 offset:32768
  s_waitcnt lgkmcnt(0)
  s_add_u32 s55, s53, 0
  buffer_store_dwordx4 v[32:35], v2, s[24:27], s55 offen offset:0 sc1
  buffer_store_dwordx4 v[36:39], v2, s[24:27], s55 offen offset:64 sc1
  s_add_u32 s55, s53, 65536
  buffer_store_dwordx4 v[40:43], v2, s[24:27], s55 offen offset:0 sc1
  buffer_store_dwordx4 v[44:47], v2, s[24:27], s55 offen offset:64 sc1
  s_add_u32 s55, s53, 131072
  buffer_store_dwordx4 v[48:51], v2, s[24:27], s55 offen offset:0 sc1
  buffer_store_dwordx4 v[52:55], v2, s[24:27], s55 offen offset:64 sc1
  s_add_u32 s55, s53, 196608
  buffer_store_dwordx4 v[56:59], v2, s[24:27], s55 offen offset:0 sc1
  buffer_store_dwordx4 v[60:63], v2, s[24:27], s55 offen offset:64 sc1
  s_waitcnt lgkmcnt(0)
  s_barrier
  s_lshl_b32 s57, s2, 8
  s_add_u32 s57, s57, 28442624
  v_and_b32 v132, 31, v0
  v_lshlrev_b32 v132, 3, v132
  v_add_u32 v132, s57, v132
  s_cmp_lt_u32 s3, 4
  s_cbranch_scc1 e2_done1
e2_conv1:
  s_sub_u32 s56, s3, 4
  s_lshr_b32 s57, s56, 1
  s_lshl_b32 s61, s2, 1
  s_add_u32 s61, s61, s57
  s_mul_i32 s56, s56, 14080
  s_add_u32 s56, s56, 98304
  v_mov_b32 v112, s56
  v_mov_b32 v116, 0
  v_mov_b32 v117, 0
  ds_write_b64 v112, v[116:117] offset:14072
  v_lshlrev_b32 v114, 2, v0
  s_lshl_b32 s57, s61, 8
  v_add_u32 v114, s57, v114
  s_lshl_b32 s57, s61, 1
  v_mov_b32 v115, s57
  global_load_dword v104, v114, s[68:69]
  global_load_dword v105, v114, s[70:71]
  global_load_dword v106, v114, s[72:73]
  global_load_dword v107, v114, s[74:75]
  global_load_dword v108, v114, s[76:77]
  global_load_dword v109, v114, s[78:79]
  global_load_ushort v110, v115, s[80:81]
  global_load_ushort v111, v115, s[82:83]
e2_done1:
  v_mov_b32 v13, 0
  s_mov_b32 s95, 0
aux_nonce:
  global_load_dwordx2 v[14:15], v13, s[10:11] sc0 sc1
  s_add_u32 s95, s95, 1
  s_waitcnt vmcnt(0)
  v_readfirstlane_b32 s96, v14
  v_readfirstlane_b32 s97, v15
  s_cmp_lg_u32 s96, 0
  s_cbranch_scc1 aux_sig
  s_cmp_lt_u32 s95, 0x200000
  s_cbranch_scc1 aux_nonce
aux_sig:
  s_waitcnt vmcnt(0) lgkmcnt(0)
  s_barrier
  s_cmp_lg_u32 s3, 0
  s_cbranch_scc1 p11_ns
  s_lshl_b32 s53, s2, 3
  s_add_u32 s53, s53, 28573696
  v_lshlrev_b32 v2, 11, v0
  v_add_u32 v2, s53, v2
  v_mov_b32 v4, s96
  v_mov_b32 v5, s97
  s_mov_b32 exec_lo, 0xff
  s_mov_b32 exec_hi, 0x0
  global_store_dwordx2 v2, v[4:5], s[8:9] sc0 sc1
  s_mov_b64 exec, -1
p11_ns:
  v_lshlrev_b32 v112, 7, v0
  s_lshl_b32 s56, s14, 18
  s_lshl_b32 s57, s3, 13
  s_add_u32 s56, s56, s57
  s_add_u32 s56, s56, 131072
  buffer_load_dword v143, v112, s[36:39], s56 offen
  s_add_u32 s56, s56, 65536
  s_cmp_ge_u32 s3, 4
  s_cbranch_scc1 s1_nw1
  v_lshrrev_b32 v112, 3, v0
  v_and_b32 v113, 7, v0
  v_lshrrev_b32 v114, 1, v112
  v_xor_b32 v113, v113, v114
  v_lshlrev_b32 v113, 4, v113
  v_lshl_add_u32 v113, v112, 12, v113
  v_xor_b32 v114, 64, v113
  s_and_b32 s56, s2, 7
  s_lshr_b32 s56, s56, 1
  s_lshl_b32 s56, s56, 3
  s_bfe_u32 s57, s2, 0x30003
  s_add_u32 s56, s56, s57
  s_lshl_b32 s56, s56, 18
  s_lshl_b32 s57, s3, 10
  s_add_u32 s56, s56, s57
  s_mul_i32 s57, s3, 24576
  s_add_u32 m0, s57, 0
  s_add_u32 s61, s56, 0
  buffer_load_dwordx4 v113, s[36:39], s61 offen lds
  s_add_u32 m0, s57, 1024
  s_add_u32 s61, s56, 32768
  buffer_load_dwordx4 v114, s[36:39], s61 offen lds
  s_add_u32 m0, s57, 2048
  s_add_u32 s61, s56, 65536
  buffer_load_dwordx4 v113, s[36:39], s61 offen lds
  s_add_u32 m0, s57, 3072
  s_add_u32 s61, s56, 98304
  buffer_load_dwordx4 v114, s[36:39], s61 offen lds
  s_add_u32 m0, s57, 4096
  s_add_u32 s61, s56, 131072
  buffer_load_dwordx4 v113, s[36:39], s61 offen lds
  s_add_u32 m0, s57, 5120
  s_add_u32 s61, s56, 163840
  buffer_load_dwordx4 v114, s[36:39], s61 offen lds
  s_add_u32 m0, s57, 6144
  s_add_u32 s61, s56, 196608
  buffer_load_dwordx4 v113, s[36:39], s61 offen lds
  s_add_u32 m0, s57, 7168
  s_add_u32 s61, s56, 229376
  buffer_load_dwordx4 v114, s[36:39], s61 offen lds
  s_add_u32 m0, s57, 8192
  s_add_u32 s61, s56, 128
  buffer_load_dwordx4 v113, s[36:39], s61 offen lds
  s_add_u32 m0, s57, 9216
  s_add_u32 s61, s56, 32896
  buffer_load_dwordx4 v114, s[36:39], s61 offen lds
  s_add_u32 m0, s57, 10240
  s_add_u32 s61, s56, 65664
  buffer_load_dwordx4 v113, s[36:39], s61 offen lds
  s_add_u32 m0, s57, 11264
  s_add_u32 s61, s56, 98432
  buffer_load_dwordx4 v114, s[36:39], s61 offen lds
  s_add_u32 m0, s57, 12288
  s_add_u32 s61, s56, 131200
  buffer_load_dwordx4 v113, s[36:39], s61 offen lds
  s_add_u32 m0, s57, 13312
  s_add_u32 s61, s56, 163968
  buffer_load_dwordx4 v114, s[36:39], s61 offen lds
  s_add_u32 m0, s57, 14336
  s_add_u32 s61, s56, 196736
  buffer_load_dwordx4 v113, s[36:39], s61 offen lds
  s_add_u32 m0, s57, 15360
  s_add_u32 s61, s56, 229504
  buffer_load_dwordx4 v114, s[36:39], s61 offen lds
s1_nw1:
  s_lshl_b32 s93, s14, 3
  s_add_u32 s93, s93, s15
  s_lshl_b32 s93, s93, 3
  s_add_u32 s93, s93, s3
  s_lshl_b32 s93, s93, 3
  s_add_u32 s93, s93, 28377088
p1_done:
  s_setprio 0
  s_and_b32 s12, s2, 7
  s_lshr_b32 s13, s2, 3
  s_lshr_b32 s14, s12, 1
  s_lshl_b32 s14, s14, 3
  s_and_b32 s15, s13, 7
  s_add_u32 s14, s14, s15
  s_and_b32 s15, s12, 1
  s_lshl_b32 s15, s15, 2
  s_lshr_b32 s13, s13, 3
  s_add_u32 s15, s15, s13
  s_waitcnt lgkmcnt(0)
  s_mov_b32 s16, s40
  s_and_b32 s17, s41, 0xffff
  s_mov_b32 s18, 8388608
  s_mov_b32 s19, 0x00020000
  s_mov_b32 s20, s8
  s_and_b32 s21, s9, 0xffff
  s_mov_b32 s22, 4194304
  s_mov_b32 s23, 0x00020000
  s_add_u32 s24, s8, 4194304
  s_addc_u32 s25, s9, 0
  s_and_b32 s25, s25, 0xffff
  s_mov_b32 s26, 4194304
  s_mov_b32 s27, 0x00020000
  s_add_u32 s28, s8, 8388608
  s_addc_u32 s29, s9, 0
  s_and_b32 s29, s29, 0xffff
  s_mov_b32 s30, 4194304
  s_mov_b32 s31, 0x00020000
  s_mov_b32 s32, s42
  s_and_b32 s33, s43, 0xffff
  s_mov_b32 s34, 4096
  s_mov_b32 s35, 0x00020000
  s_add_u32 s36, s8, 12582912
  s_addc_u32 s37, s9, 0
  s_and_b32 s37, s37, 0xffff
  s_mov_b32 s38, 2097152
  s_mov_b32 s39, 0x00020000
  s_add_u32 s40, s8, 14680064
  s_addc_u32 s41, s9, 0
  s_and_b32 s41, s41, 0xffff
  s_mov_b32 s42, 2097152
  s_mov_b32 s43, 0x00020000
  s_cmp_ge_u32 s3, 4
  s_cbranch_scc1 k2_conv
  v_lshrrev_b32 v20, 3, v0
  v_and_b32 v21, 7, v0
  v_lshrrev_b32 v22, 1, v20
  v_xor_b32 v21, v21, v22
  v_lshlrev_b32 v21, 4, v21
  v_lshl_add_u32 v21, v20, 12, v21
  v_xor_b32 v22, 64, v21
  v_add_u32 v2, 0, v21
  v_add_u32 v3, 31744, v22
  v_add_u32 v4, 63488, v21
  v_add_u32 v5, 95232, v22
  v_add_u32 v6, 131072, v21
  v_add_u32 v7, 162816, v22
  v_add_u32 v8, 194560, v21
  v_add_u32 v9, 226304, v22
  v_lshlrev_b32 v10, 4, v0
  v_add_u32 v11, 4096, v10
  v_and_b32 v20, 15, v0
  v_lshrrev_b32 v21, 4, v0
  v_lshrrev_b32 v22, 1, v20
  v_xor_b32 v21, v21, v22
  v_lshlrev_b32 v21, 4, v21
  v_lshl_add_u32 v21, v20, 7, v21
  s_mul_i32 s52, s3, 24576
  s_add_u32 s53, s3, 0
  s_and_b32 s53, s53, 3
  s_lshl_b32 s53, s53, 11
  s_add_u32 s53, s53, s52
  v_add_u32 v12, s53, v21
  v_xor_b32 v16, 64, v12
  s_add_u32 s53, s3, 1
  s_and_b32 s53, s53, 3
  s_lshl_b32 s53, s53, 11
  s_add_u32 s53, s53, s52
  v_add_u32 v13, s53, v21
  v_xor_b32 v17, 64, v13
  s_add_u32 s53, s3, 2
  s_and_b32 s53, s53, 3
  s_lshl_b32 s53, s53, 11
  s_add_u32 s53, s53, s52
  v_add_u32 v14, s53, v21
  v_xor_b32 v18, 64, v14
  s_add_u32 s53, s3, 3
  s_and_b32 s53, s53, 3
  s_lshl_b32 s53, s53, 11
  s_add_u32 s53, s53, s52
  v_add_u32 v15, s53, v21
  v_xor_b32 v19, 64, v15
  s_lshl_b32 s54, s14, 18
  s_lshl_b32 s53, s3, 10
  s_add_u32 s54, s54, s53
  s_mul_i32 s55, s15, 458752
  s_mul_i32 s53, s3, 114688
  s_add_u32 s55, s55, s53
  v_mov_b32 v22, 112376
  s_cmp_lg_u32 s3, 0
  s_cbranch_scc1 p2_lw
  s_and_b32 s53, s2, 7
  s_lshl_b32 s53, s53, 11
  s_add_u32 s53, s53, 28573696
  v_lshlrev_b32 v20, 4, v0
  v_add_u32 v20, s53, v20
  s_mov_b32 s95, 0
p2_zpoll:
  global_load_dwordx4 v[28:31], v20, s[8:9] sc0 sc1
  global_load_dwordx4 v[32:35], v20, s[8:9] offset:1024 sc0 sc1
  s_add_u32 s95, s95, 1
  s_waitcnt vmcnt(0)
  v_cmp_ne_u64 s[62:63], s[96:97], v[28:29]
  v_cmp_ne_u64 s[64:65], s[96:97], v[30:31]
  v_cmp_ne_u64 s[66:67], s[96:97], v[32:33]
  v_cmp_ne_u64 vcc, s[96:97], v[34:35]
  s_nop 1
  s_or_b64 s[62:63], s[62:63], s[64:65]
  s_or_b64 s[66:67], s[66:67], vcc
  s_or_b64 s[62:63], s[62:63], s[66:67]
  s_cmp_eq_u64 s[62:63], 0
  s_cbranch_scc1 p2_set
  s_sleep 4
  s_cmp_lt_u32 s95, 0x100000
  s_cbranch_scc1 p2_zpoll
p2_set:
  s_lshl_b32 s62, s2, 13
  v_lshlrev_b32 v20, 4, v0
  s_mov_b32 m0, 155136
  s_nop 0
  buffer_load_dwordx4 v20, s[36:39], s62 offen offset:0 sc1 lds
  buffer_load_dwordx4 v20, s[36:39], s62 offen offset:1024 sc1 lds
  buffer_load_dwordx4 v20, s[36:39], s62 offen offset:2048 sc1 lds
  buffer_load_dwordx4 v20, s[36:39], s62 offen offset:3072 sc1 lds
  s_mov_b32 m0, 159744
  s_add_u32 s62, s62, 4096
  buffer_load_dwordx4 v20, s[36:39], s62 offen offset:0 sc1 lds
  buffer_load_dwordx4 v20, s[36:39], s62 offen offset:1024 sc1 lds
  buffer_load_dwordx4 v20, s[36:39], s62 offen offset:2048 sc1 lds
  buffer_load_dwordx4 v20, s[36:39], s62 offen offset:3072 sc1 lds
  v_mov_b32 v23, 1
  ds_write_b32 v22, v23
  s_branch p2_go
p2_lw:
  s_mov_b32 s95, 0
p2_lwl:
  ds_read_b32 v23, v22
  s_add_u32 s95, s95, 1
  s_waitcnt lgkmcnt(0)
  v_readfirstlane_b32 s94, v23
  s_cmp_eq_u32 s94, 1
  s_cbranch_scc1 p2_lwl_ok
  s_sleep 1
  s_cmp_lt_u32 s95, 0x1000000
  s_cbranch_scc1 p2_lwl
p2_lwl_ok:
p2_go:
  s_add_u32 s57, s55, 0
  buffer_load_dwordx4 v[60:63], v10, s[20:23], s57 offen offset:0 sc1
  buffer_load_dwordx4 v[64:67], v10, s[20:23], s57 offen offset:1024 sc1
  buffer_load_dwordx4 v[68:71], v10, s[20:23], s57 offen offset:2048 sc1
  buffer_load_dwordx4 v[72:75], v10, s[20:23], s57 offen offset:3072 sc1
  buffer_load_dwordx4 v[76:79], v11, s[20:23], s57 offen offset:0 sc1
  buffer_load_dwordx4 v[80:83], v11, s[20:23], s57 offen offset:1024 sc1
  buffer_load_dwordx4 v[84:87], v11, s[20:23], s57 offen offset:2048 sc1
  s_add_u32 s57, s55, 7168
  buffer_load_dwordx4 v[88:91], v10, s[20:23], s57 offen offset:0 sc1
  buffer_load_dwordx4 v[92:95], v10, s[20:23], s57 offen offset:1024 sc1
  buffer_load_dwordx4 v[96:99], v10, s[20:23], s57 offen offset:2048 sc1
  buffer_load_dwordx4 v[100:103], v10, s[20:23], s57 offen offset:3072 sc1
  buffer_load_dwordx4 v[104:107], v11, s[20:23], s57 offen offset:0 sc1
  buffer_load_dwordx4 v[108:111], v11, s[20:23], s57 offen offset:1024 sc1
  buffer_load_dwordx4 v[112:115], v11, s[20:23], s57 offen offset:2048 sc1
  s_waitcnt vmcnt(14)
  ds_read_b128 v[28:31], v12 offset:0
  ds_read_b128 v[32:35], v13 offset:0
  ds_read_b128 v[36:39], v14 offset:0
  ds_read_b128 v[40:43], v15 offset:0
  s_waitcnt vmcnt(7)
  s_cmp_lg_u32 s3, 0
  s_cbranch_scc1 p2_xs
  v_mov_b32 v21, 126456
  v_mov_b32 v22, 1
  ds_write_b32 v21, v22
p2_xs:
  s_waitcnt lgkmcnt(0)
  v_mfma_f32_16x16x32_bf16 a[0:3], v[60:63], v[28:31], 0
  ds_read_b128 v[44:47], v16 offset:0
  v_mfma_f32_16x16x32_bf16 a[4:7], v[60:63], v[32:35], 0
  ds_read_b128 v[48:51], v17 offset:0
  v_mfma_f32_16x16x32_bf16 a[8:11], v[60:63], v[36:39], 0
  ds_read_b128 v[52:55], v18 offset:0
  v_mfma_f32_16x16x32_bf16 a[12:15], v[60:63], v[40:43], 0
  ds_read_b128 v[56:59], v19 offset:0
  v_mfma_f32_16x16x32_bf16 a[16:19], v[64:67], v[28:31], 0
  s_add_u32 s57, s55, 14336
  buffer_load_dwordx4 v[116:119], v10, s[20:23], s57 offen offset:0 sc1
  v_mfma_f32_16x16x32_bf16 a[20:23], v[64:67], v[32:35], 0
  buffer_load_dwordx4 v[120:123], v10, s[20:23], s57 offen offset:1024 sc1
  v_mfma_f32_16x16x32_bf16 a[24:27], v[64:67], v[36:39], 0
  buffer_load_dwordx4 v[124:127], v10, s[20:23], s57 offen offset:2048 sc1
  v_mfma_f32_16x16x32_bf16 a[28:31], v[64:67], v[40:43], 0
  buffer_load_dwordx4 v[128:131], v10, s[20:23], s57 offen offset:3072 sc1
  v_mfma_f32_16x16x32_bf16 a[32:35], v[68:71], v[28:31], 0
  buffer_load_dwordx4 v[132:135], v11, s[20:23], s57 offen offset:0 sc1
  v_mfma_f32_16x16x32_bf16 a[36:39], v[68:71], v[32:35], 0
  buffer_load_dwordx4 v[136:139], v11, s[20:23], s57 offen offset:1024 sc1
  v_mfma_f32_16x16x32_bf16 a[40:43], v[68:71], v[36:39], 0
  buffer_load_dwordx4 v[140:143], v11, s[20:23], s57 offen offset:2048 sc1
  v_mfma_f32_16x16x32_bf16 a[44:47], v[68:71], v[40:43], 0
  s_add_u32 m0, s52, 16384
  s_add_u32 s56, s54, 256
  buffer_load_dwordx4 v2, s[16:19], s56 offen offset:0 lds
  v_mfma_f32_16x16x32_bf16 a[48:51], v[72:75], v[28:31], 0
  buffer_load_dwordx4 v3, s[16:19], s56 offen offset:1024 lds
  v_mfma_f32_16x16x32_bf16 a[52:55], v[72:75], v[32:35], 0
  buffer_load_dwordx4 v4, s[16:19], s56 offen offset:2048 lds
  v_mfma_f32_16x16x32_bf16 a[56:59], v[72:75], v[36:39], 0
  buffer_load_dwordx4 v5, s[16:19], s56 offen offset:3072 lds
  v_mfma_f32_16x16x32_bf16 a[60:63], v[72:75], v[40:43], 0
  s_add_u32 m0, s52, 20480
  s_nop 0
  buffer_load_dwordx4 v6, s[16:19], s56 offen offset:0 lds
  v_mfma_f32_16x16x32_bf16 a[64:67], v[76:79], v[28:31], 0
  buffer_load_dwordx4 v7, s[16:19], s56 offen offset:1024 lds
  v_mfma_f32_16x16x32_bf16 a[68:71], v[76:79], v[32:35], 0
  buffer_load_dwordx4 v8, s[16:19], s56 offen offset:2048 lds
  v_mfma_f32_16x16x32_bf16 a[72:75], v[76:79], v[36:39], 0
  buffer_load_dwordx4 v9, s[16:19], s56 offen offset:3072 lds
  v_mfma_f32_16x16x32_bf16 a[76:79], v[76:79], v[40:43], 0
  v_mfma_f32_16x16x32_bf16 a[80:83], v[80:83], v[28:31], 0
  v_mfma_f32_16x16x32_bf16 a[84:87], v[80:83], v[32:35], 0
  v_mfma_f32_16x16x32_bf16 a[88:91], v[80:83], v[36:39], 0
  v_mfma_f32_16x16x32_bf16 a[92:95], v[80:83], v[40:43], 0
  v_mfma_f32_16x16x32_bf16 a[96:99], v[84:87], v[28:31], 0
  v_mfma_f32_16x16x32_bf16 a[100:103], v[84:87], v[32:35], 0
  v_mfma_f32_16x16x32_bf16 a[104:107], v[84:87], v[36:39], 0
  v_mfma_f32_16x16x32_bf16 a[108:111], v[84:87], v[40:43], 0
  s_waitcnt vmcnt(15)
  s_waitcnt lgkmcnt(0)
  v_mfma_f32_16x16x32_bf16 a[0:3], v[88:91], v[44:47], a[0:3]
  ds_read_b128 v[28:31], v12 offset:8192
  v_mfma_f32_16x16x32_bf16 a[4:7], v[88:91], v[48:51], a[4:7]
  ds_read_b128 v[32:35], v13 offset:8192
  v_mfma_f32_16x16x32_bf16 a[8:11], v[88:91], v[52:55], a[8:11]
  ds_read_b128 v[36:39], v14 offset:8192
  v_mfma_f32_16x16x32_bf16 a[12:15], v[88:91], v[56:59], a[12:15]
  ds_read_b128 v[40:43], v15 offset:8192
  v_mfma_f32_16x16x32_bf16 a[16:19], v[92:95], v[44:47], a[16:19]
  s_add_u32 s57, s55, 21504
  buffer_load_dwordx4 v[60:63], v10, s[20:23], s57 offen offset:0 sc1
  v_mfma_f32_16x16x32_bf16 a[20:23], v[92:95], v[48:51], a[20:23]
  buffer_load_dwordx4 v[64:67], v10, s[20:23], s57 offen offset:1024 sc1
  v_mfma_f32_16x16x32_bf16 a[24:27], v[92:95], v[52:55], a[24:27]
  buffer_load_dwordx4 v[68:71], v10, s[20:23], s57 offen offset:2048 sc1
  v_mfma_f32_16x16x32_bf16 a[28:31], v[92:95], v[56:59], a[28:31]
  buffer_load_dwordx4 v[72:75], v10, s[20:23], s57 offen offset:3072 sc1
  v_mfma_f32_16x16x32_bf16 a[32:35], v[96:99], v[44:47], a[32:35]
  buffer_load_dwordx4 v[76:79], v11, s[20:23], s57 offen offset:0 sc1
  v_mfma_f32_16x16x32_bf16 a[36:39], v[96:99], v[48:51], a[36:39]
  buffer_load_dwordx4 v[80:83], v11, s[20:23], s57 offen offset:1024 sc1
  v_mfma_f32_16x16x32_bf16 a[40:43], v[96:99], v[52:55], a[40:43]
  buffer_load_dwordx4 v[84:87], v11, s[20:23], s57 offen offset:2048 sc1
  v_mfma_f32_16x16x32_bf16 a[44:47], v[96:99], v[56:59], a[44:47]
  v_mfma_f32_16x16x32_bf16 a[48:51], v[100:103], v[44:47], a[48:51]
  v_mfma_f32_16x16x32_bf16 a[52:55], v[100:103], v[48:51], a[52:55]
  v_mfma_f32_16x16x32_bf16 a[56:59], v[100:103], v[52:55], a[56:59]
  v_mfma_f32_16x16x32_bf16 a[60:63], v[100:103], v[56:59], a[60:63]
  v_mfma_f32_16x16x32_bf16 a[64:67], v[104:107], v[44:47], a[64:67]
  v_mfma_f32_16x16x32_bf16 a[68:71], v[104:107], v[48:51], a[68:71]
  v_mfma_f32_16x16x32_bf16 a[72:75], v[104:107], v[52:55], a[72:75]
  v_mfma_f32_16x16x32_bf16 a[76:79], v[104:107], v[56:59], a[76:79]
  v_mfma_f32_16x16x32_bf16 a[80:83], v[108:111], v[44:47], a[80:83]
  v_mfma_f32_16x16x32_bf16 a[84:87], v[108:111], v[48:51], a[84:87]
  v_mfma_f32_16x16x32_bf16 a[88:91], v[108:111], v[52:55], a[88:91]
  v_mfma_f32_16x16x32_bf16 a[92:95], v[108:111], v[56:59], a[92:95]
  v_mfma_f32_16x16x32_bf16 a[96:99], v[112:115], v[44:47], a[96:99]
  v_mfma_f32_16x16x32_bf16 a[100:103], v[112:115], v[48:51], a[100:103]
  v_mfma_f32_16x16x32_bf16 a[104:107], v[112:115], v[52:55], a[104:107]
  v_mfma_f32_16x16x32_bf16 a[108:111], v[112:115], v[56:59], a[108:111]
  s_waitcnt vmcnt(15)
  s_waitcnt lgkmcnt(0)
  v_mfma_f32_16x16x32_bf16 a[0:3], v[116:119], v[28:31], a[0:3]
  ds_read_b128 v[44:47], v16 offset:8192
  v_mfma_f32_16x16x32_bf16 a[4:7], v[116:119], v[32:35], a[4:7]
  ds_read_b128 v[48:51], v17 offset:8192
  v_mfma_f32_16x16x32_bf16 a[8:11], v[116:119], v[36:39], a[8:11]
  ds_read_b128 v[52:55], v18 offset:8192
  v_mfma_f32_16x16x32_bf16 a[12:15], v[116:119], v[40:43], a[12:15]
  ds_read_b128 v[56:59], v19 offset:8192
  v_mfma_f32_16x16x32_bf16 a[16:19], v[120:123], v[28:31], a[16:19]
  s_add_u32 s57, s55, 28672
  buffer_load_dwordx4 v[88:91], v10, s[20:23], s57 offen offset:0 sc1
  v_mfma_f32_16x16x32_bf16 a[20:23], v[120:123], v[32:35], a[20:23]
  buffer_load_dwordx4 v[92:95], v10, s[20:23], s57 offen offset:1024 sc1
  v_mfma_f32_16x16x32_bf16 a[24:27], v[120:123], v[36:39], a[24:27]
  buffer_load_dwordx4 v[96:99], v10, s[20:23], s57 offen offset:2048 sc1
  v_mfma_f32_16x16x32_bf16 a[28:31], v[120:123], v[40:43], a[28:31]
  buffer_load_dwordx4 v[100:103], v10, s[20:23], s57 offen offset:3072 sc1
  v_mfma_f32_16x16x32_bf16 a[32:35], v[124:127], v[28:31], a[32:35]
  buffer_load_dwordx4 v[104:107], v11, s[20:23], s57 offen offset:0 sc1
  v_mfma_f32_16x16x32_bf16 a[36:39], v[124:127], v[32:35], a[36:39]
  buffer_load_dwordx4 v[108:111], v11, s[20:23], s57 offen offset:1024 sc1
  v_mfma_f32_16x16x32_bf16 a[40:43], v[124:127], v[36:39], a[40:43]
  buffer_load_dwordx4 v[112:115], v11, s[20:23], s57 offen offset:2048 sc1
  v_mfma_f32_16x16x32_bf16 a[44:47], v[124:127], v[40:43], a[44:47]
  s_add_u32 m0, s52, 0
  s_add_u32 s56, s54, 384
  buffer_load_dwordx4 v2, s[16:19], s56 offen offset:0 lds
  v_mfma_f32_16x16x32_bf16 a[48:51], v[128:131], v[28:31], a[48:51]
  buffer_load_dwordx4 v3, s[16:19], s56 offen offset:1024 lds
  v_mfma_f32_16x16x32_bf16 a[52:55], v[128:131], v[32:35], a[52:55]
  buffer_load_dwordx4 v4, s[16:19], s56 offen offset:2048 lds
  v_mfma_f32_16x16x32_bf16 a[56:59], v[128:131], v[36:39], a[56:59]
  buffer_load_dwordx4 v5, s[16:19], s56 offen offset:3072 lds
  v_mfma_f32_16x16x32_bf16 a[60:63], v[128:131], v[40:43], a[60:63]
  s_add_u32 m0, s52, 4096
  s_nop 0
  buffer_load_dwordx4 v6, s[16:19], s56 offen offset:0 lds
  v_mfma_f32_16x16x32_bf16 a[64:67], v[132:135], v[28:31], a[64:67]
  buffer_load_dwordx4 v7, s[16:19], s56 offen offset:1024 lds
  v_mfma_f32_16x16x32_bf16 a[68:71], v[132:135], v[32:35], a[68:71]
  buffer_load_dwordx4 v8, s[16:19], s56 offen offset:2048 lds
  v_mfma_f32_16x16x32_bf16 a[72:75], v[132:135], v[36:39], a[72:75]
  buffer_load_dwordx4 v9, s[16:19], s56 offen offset:3072 lds
  v_mfma_f32_16x16x32_bf16 a[76:79], v[132:135], v[40:43], a[76:79]
  v_mfma_f32_16x16x32_bf16 a[80:83], v[136:139], v[28:31], a[80:83]
  v_mfma_f32_16x16x32_bf16 a[84:87], v[136:139], v[32:35], a[84:87]
  v_mfma_f32_16x16x32_bf16 a[88:91], v[136:139], v[36:39], a[88:91]
  v_mfma_f32_16x16x32_bf16 a[92:95], v[136:139], v[40:43], a[92:95]
  v_mfma_f32_16x16x32_bf16 a[96:99], v[140:143], v[28:31], a[96:99]
  v_mfma_f32_16x16x32_bf16 a[100:103], v[140:143], v[32:35], a[100:103]
  v_mfma_f32_16x16x32_bf16 a[104:107], v[140:143], v[36:39], a[104:107]
  v_mfma_f32_16x16x32_bf16 a[108:111], v[140:143], v[40:43], a[108:111]
  s_waitcnt vmcnt(15)
  s_waitcnt lgkmcnt(0)
  v_mfma_f32_16x16x32_bf16 a[0:3], v[60:63], v[44:47], a[0:3]
  ds_read_b128 v[28:31], v12 offset:16384
  v_mfma_f32_16x16x32_bf16 a[4:7], v[60:63], v[48:51], a[4:7]
  ds_read_b128 v[32:35], v13 offset:16384
  v_mfma_f32_16x16x32_bf16 a[8:11], v[60:63], v[52:55], a[8:11]
  ds_read_b128 v[36:39], v14 offset:16384
  v_mfma_f32_16x16x32_bf16 a[12:15], v[60:63], v[56:59], a[12:15]
  ds_read_b128 v[40:43], v15 offset:16384
  v_mfma_f32_16x16x32_bf16 a[16:19], v[64:67], v[44:47], a[16:19]
  s_add_u32 s57, s55, 35840
  buffer_load_dwordx4 v[116:119], v10, s[20:23], s57 offen offset:0 sc1
  v_mfma_f32_16x16x32_bf16 a[20:23], v[64:67], v[48:51], a[20:23]
  buffer_load_dwordx4 v[120:123], v10, s[20:23], s57 offen offset:1024 sc1
  v_mfma_f32_16x16x32_bf16 a[24:27], v[64:67], v[52:55], a[24:27]
  buffer_load_dwordx4 v[124:127], v10, s[20:23], s57 offen offset:2048 sc1
  v_mfma_f32_16x16x32_bf16 a[28:31], v[64:67], v[56:59], a[28:31]
  buffer_load_dwordx4 v[128:131], v10, s[20:23], s57 offen offset:3072 sc1
  v_mfma_f32_16x16x32_bf16 a[32:35], v[68:71], v[44:47], a[32:35]
  buffer_load_dwordx4 v[132:135], v11, s[20:23], s57 offen offset:0 sc1
  v_mfma_f32_16x16x32_bf16 a[36:39], v[68:71], v[48:51], a[36:39]
  buffer_load_dwordx4 v[136:139], v11, s[20:23], s57 offen offset:1024 sc1
  v_mfma_f32_16x16x32_bf16 a[40:43], v[68:71], v[52:55], a[40:43]
  buffer_load_dwordx4 v[140:143], v11, s[20:23], s57 offen offset:2048 sc1
  v_mfma_f32_16x16x32_bf16 a[44:47], v[68:71], v[56:59], a[44:47]
  v_mfma_f32_16x16x32_bf16 a[48:51], v[72:75], v[44:47], a[48:51]
  v_mfma_f32_16x16x32_bf16 a[52:55], v[72:75], v[48:51], a[52:55]
  v_mfma_f32_16x16x32_bf16 a[56:59], v[72:75], v[52:55], a[56:59]
  v_mfma_f32_16x16x32_bf16 a[60:63], v[72:75], v[56:59], a[60:63]
  v_mfma_f32_16x16x32_bf16 a[64:67], v[76:79], v[44:47], a[64:67]
  v_mfma_f32_16x16x32_bf16 a[68:71], v[76:79], v[48:51], a[68:71]
  v_mfma_f32_16x16x32_bf16 a[72:75], v[76:79], v[52:55], a[72:75]
  v_mfma_f32_16x16x32_bf16 a[76:79], v[76:79], v[56:59], a[76:79]
  v_mfma_f32_16x16x32_bf16 a[80:83], v[80:83], v[44:47], a[80:83]
  v_mfma_f32_16x16x32_bf16 a[84:87], v[80:83], v[48:51], a[84:87]
  v_mfma_f32_16x16x32_bf16 a[88:91], v[80:83], v[52:55], a[88:91]
  v_mfma_f32_16x16x32_bf16 a[92:95], v[80:83], v[56:59], a[92:95]
  v_mfma_f32_16x16x32_bf16 a[96:99], v[84:87], v[44:47], a[96:99]
  v_mfma_f32_16x16x32_bf16 a[100:103], v[84:87], v[48:51], a[100:103]
  v_mfma_f32_16x16x32_bf16 a[104:107], v[84:87], v[52:55], a[104:107]
  v_mfma_f32_16x16x32_bf16 a[108:111], v[84:87], v[56:59], a[108:111]
  s_waitcnt vmcnt(15)
  s_waitcnt lgkmcnt(0)
  v_mfma_f32_16x16x32_bf16 a[0:3], v[88:91], v[28:31], a[0:3]
  ds_read_b128 v[44:47], v16 offset:16384
  v_mfma_f32_16x16x32_bf16 a[4:7], v[88:91], v[32:35], a[4:7]
  ds_read_b128 v[48:51], v17 offset:16384
  v_mfma_f32_16x16x32_bf16 a[8:11], v[88:91], v[36:39], a[8:11]
  ds_read_b128 v[52:55], v18 offset:16384
  v_mfma_f32_16x16x32_bf16 a[12:15], v[88:91], v[40:43], a[12:15]
  ds_read_b128 v[56:59], v19 offset:16384
  v_mfma_f32_16x16x32_bf16 a[16:19], v[92:95], v[28:31], a[16:19]
  s_add_u32 s57, s55, 43008
  buffer_load_dwordx4 v[60:63], v10, s[20:23], s57 offen offset:0 sc1
  v_mfma_f32_16x16x32_bf16 a[20:23], v[92:95], v[32:35], a[20:23]
  buffer_load_dwordx4 v[64:67], v10, s[20:23], s57 offen offset:1024 sc1
  v_mfma_f32_16x16x32_bf16 a[24:27], v[92:95], v[36:39], a[24:27]
  buffer_load_dwordx4 v[68:71], v10, s[20:23], s57 offen offset:2048 sc1
  v_mfma_f32_16x16x32_bf16 a[28:31], v[92:95], v[40:43], a[28:31]
  buffer_load_dwordx4 v[72:75], v10, s[20:23], s57 offen offset:3072 sc1
  v_mfma_f32_16x16x32_bf16 a[32:35], v[96:99], v[28:31], a[32:35]
  buffer_load_dwordx4 v[76:79], v11, s[20:23], s57 offen offset:0 sc1
  v_mfma_f32_16x16x32_bf16 a[36:39], v[96:99], v[32:35], a[36:39]
  buffer_load_dwordx4 v[80:83], v11, s[20:23], s57 offen offset:1024 sc1
  v_mfma_f32_16x16x32_bf16 a[40:43], v[96:99], v[36:39], a[40:43]
  buffer_load_dwordx4 v[84:87], v11, s[20:23], s57 offen offset:2048 sc1
  v_mfma_f32_16x16x32_bf16 a[44:47], v[96:99], v[40:43], a[44:47]
  s_add_u32 m0, s52, 8192
  s_add_u32 s56, s54, 512
  buffer_load_dwordx4 v2, s[16:19], s56 offen offset:0 lds
  v_mfma_f32_16x16x32_bf16 a[48:51], v[100:103], v[28:31], a[48:51]
  buffer_load_dwordx4 v3, s[16:19], s56 offen offset:1024 lds
  v_mfma_f32_16x16x32_bf16 a[52:55], v[100:103], v[32:35], a[52:55]
  buffer_load_dwordx4 v4, s[16:19], s56 offen offset:2048 lds
  v_mfma_f32_16x16x32_bf16 a[56:59], v[100:103], v[36:39], a[56:59]
  buffer_load_dwordx4 v5, s[16:19], s56 offen offset:3072 lds
  v_mfma_f32_16x16x32_bf16 a[60:63], v[100:103], v[40:43], a[60:63]
  s_add_u32 m0, s52, 12288
  s_nop 0
  buffer_load_dwordx4 v6, s[16:19], s56 offen offset:0 lds
  v_mfma_f32_16x16x32_bf16 a[64:67], v[104:107], v[28:31], a[64:67]
  buffer_load_dwordx4 v7, s[16:19], s56 offen offset:1024 lds
  v_mfma_f32_16x16x32_bf16 a[68:71], v[104:107], v[32:35], a[68:71]
  buffer_load_dwordx4 v8, s[16:19], s56 offen offset:2048 lds
  v_mfma_f32_16x16x32_bf16 a[72:75], v[104:107], v[36:39], a[72:75]
  buffer_load_dwordx4 v9, s[16:19], s56 offen offset:3072 lds
  v_mfma_f32_16x16x32_bf16 a[76:79], v[104:107], v[40:43], a[76:79]
  v_mfma_f32_16x16x32_bf16 a[80:83], v[108:111], v[28:31], a[80:83]
  v_mfma_f32_16x16x32_bf16 a[84:87], v[108:111], v[32:35], a[84:87]
  v_mfma_f32_16x16x32_bf16 a[88:91], v[108:111], v[36:39], a[88:91]
  v_mfma_f32_16x16x32_bf16 a[92:95], v[108:111], v[40:43], a[92:95]
  v_mfma_f32_16x16x32_bf16 a[96:99], v[112:115], v[28:31], a[96:99]
  v_mfma_f32_16x16x32_bf16 a[100:103], v[112:115], v[32:35], a[100:103]
  v_mfma_f32_16x16x32_bf16 a[104:107], v[112:115], v[36:39], a[104:107]
  v_mfma_f32_16x16x32_bf16 a[108:111], v[112:115], v[40:43], a[108:111]
  s_waitcnt vmcnt(15)
  s_waitcnt lgkmcnt(0)
  v_mfma_f32_16x16x32_bf16 a[0:3], v[116:119], v[44:47], a[0:3]
  ds_read_b128 v[28:31], v12 offset:0
  v_mfma_f32_16x16x32_bf16 a[4:7], v[116:119], v[48:51], a[4:7]
  ds_read_b128 v[32:35], v13 offset:0
  v_mfma_f32_16x16x32_bf16 a[8:11], v[116:119], v[52:55], a[8:11]
  ds_read_b128 v[36:39], v14 offset:0
  v_mfma_f32_16x16x32_bf16 a[12:15], v[116:119], v[56:59], a[12:15]
  ds_read_b128 v[40:43], v15 offset:0
  v_mfma_f32_16x16x32_bf16 a[16:19], v[120:123], v[44:47], a[16:19]
  s_add_u32 s57, s55, 50176
  buffer_load_dwordx4 v[88:91], v10, s[20:23], s57 offen offset:0 sc1
  v_mfma_f32_16x16x32_bf16 a[20:23], v[120:123], v[48:51], a[20:23]
  buffer_load_dwordx4 v[92:95], v10, s[20:23], s57 offen offset:1024 sc1
  v_mfma_f32_16x16x32_bf16 a[24:27], v[120:123], v[52:55], a[24:27]
  buffer_load_dwordx4 v[96:99], v10, s[20:23], s57 offen offset:2048 sc1
  v_mfma_f32_16x16x32_bf16 a[28:31], v[120:123], v[56:59], a[28:31]
  buffer_load_dwordx4 v[100:103], v10, s[20:23], s57 offen offset:3072 sc1
  v_mfma_f32_16x16x32_bf16 a[32:35], v[124:127], v[44:47], a[32:35]
  buffer_load_dwordx4 v[104:107], v11, s[20:23], s57 offen offset:0 sc1
  v_mfma_f32_16x16x32_bf16 a[36:39], v[124:127], v[48:51], a[36:39]
  buffer_load_dwordx4 v[108:111], v11, s[20:23], s57 offen offset:1024 sc1
  v_mfma_f32_16x16x32_bf16 a[40:43], v[124:127], v[52:55], a[40:43]
  buffer_load_dwordx4 v[112:115], v11, s[20:23], s57 offen offset:2048 sc1
  v_mfma_f32_16x16x32_bf16 a[44:47], v[124:127], v[56:59], a[44:47]
  v_mfma_f32_16x16x32_bf16 a[48:51], v[128:131], v[44:47], a[48:51]
  v_mfma_f32_16x16x32_bf16 a[52:55], v[128:131], v[48:51], a[52:55]
  v_mfma_f32_16x16x32_bf16 a[56:59], v[128:131], v[52:55], a[56:59]
  v_mfma_f32_16x16x32_bf16 a[60:63], v[128:131], v[56:59], a[60:63]
  v_mfma_f32_16x16x32_bf16 a[64:67], v[132:135], v[44:47], a[64:67]
  v_mfma_f32_16x16x32_bf16 a[68:71], v[132:135], v[48:51], a[68:71]
  v_mfma_f32_16x16x32_bf16 a[72:75], v[132:135], v[52:55], a[72:75]
  v_mfma_f32_16x16x32_bf16 a[76:79], v[132:135], v[56:59], a[76:79]
  v_mfma_f32_16x16x32_bf16 a[80:83], v[136:139], v[44:47], a[80:83]
  v_mfma_f32_16x16x32_bf16 a[84:87], v[136:139], v[48:51], a[84:87]
  v_mfma_f32_16x16x32_bf16 a[88:91], v[136:139], v[52:55], a[88:91]
  v_mfma_f32_16x16x32_bf16 a[92:95], v[136:139], v[56:59], a[92:95]
  v_mfma_f32_16x16x32_bf16 a[96:99], v[140:143], v[44:47], a[96:99]
  v_mfma_f32_16x16x32_bf16 a[100:103], v[140:143], v[48:51], a[100:103]
  v_mfma_f32_16x16x32_bf16 a[104:107], v[140:143], v[52:55], a[104:107]
  v_mfma_f32_16x16x32_bf16 a[108:111], v[140:143], v[56:59], a[108:111]
  s_waitcnt vmcnt(15)
  s_waitcnt lgkmcnt(0)
  v_mfma_f32_16x16x32_bf16 a[0:3], v[60:63], v[28:31], a[0:3]
  ds_read_b128 v[44:47], v16 offset:0
  v_mfma_f32_16x16x32_bf16 a[4:7], v[60:63], v[32:35], a[4:7]
  ds_read_b128 v[48:51], v17 offset:0
  v_mfma_f32_16x16x32_bf16 a[8:11], v[60:63], v[36:39], a[8:11]
  ds_read_b128 v[52:55], v18 offset:0
  v_mfma_f32_16x16x32_bf16 a[12:15], v[60:63], v[40:43], a[12:15]
  ds_read_b128 v[56:59], v19 offset:0
  v_mfma_f32_16x16x32_bf16 a[16:19], v[64:67], v[28:31], a[16:19]
  s_add_u32 s57, s55, 57344
  buffer_load_dwordx4 v[116:119], v10, s[20:23], s57 offen offset:0 sc1
  v_mfma_f32_16x16x32_bf16 a[20:23], v[64:67], v[32:35], a[20:23]
  buffer_load_dwordx4 v[120:123], v10, s[20:23], s57 offen offset:1024 sc1
  v_mfma_f32_16x16x32_bf16 a[24:27], v[64:67], v[36:39], a[24:27]
  buffer_load_dwordx4 v[124:127], v10, s[20:23], s57 offen offset:2048 sc1
  v_mfma_f32_16x16x32_bf16 a[28:31], v[64:67], v[40:43], a[28:31]
  buffer_load_dwordx4 v[128:131], v10, s[20:23], s57 offen offset:3072 sc1
  v_mfma_f32_16x16x32_bf16 a[32:35], v[68:71], v[28:31], a[32:35]
  buffer_load_dwordx4 v[132:135], v11, s[20:23], s57 offen offset:0 sc1
  v_mfma_f32_16x16x32_bf16 a[36:39], v[68:71], v[32:35], a[36:39]
  buffer_load_dwordx4 v[136:139], v11, s[20:23], s57 offen offset:1024 sc1
  v_mfma_f32_16x16x32_bf16 a[40:43], v[68:71], v[36:39], a[40:43]
  buffer_load_dwordx4 v[140:143], v11, s[20:23], s57 offen offset:2048 sc1
  v_mfma_f32_16x16x32_bf16 a[44:47], v[68:71], v[40:43], a[44:47]
  s_add_u32 m0, s52, 16384
  s_add_u32 s56, s54, 640
  buffer_load_dwordx4 v2, s[16:19], s56 offen offset:0 lds
  v_mfma_f32_16x16x32_bf16 a[48:51], v[72:75], v[28:31], a[48:51]
  buffer_load_dwordx4 v3, s[16:19], s56 offen offset:1024 lds
  v_mfma_f32_16x16x32_bf16 a[52:55], v[72:75], v[32:35], a[52:55]
  buffer_load_dwordx4 v4, s[16:19], s56 offen offset:2048 lds
  v_mfma_f32_16x16x32_bf16 a[56:59], v[72:75], v[36:39], a[56:59]
  buffer_load_dwordx4 v5, s[16:19], s56 offen offset:3072 lds
  v_mfma_f32_16x16x32_bf16 a[60:63], v[72:75], v[40:43], a[60:63]
  s_add_u32 m0, s52, 20480
  s_nop 0
  buffer_load_dwordx4 v6, s[16:19], s56 offen offset:0 lds
  v_mfma_f32_16x16x32_bf16 a[64:67], v[76:79], v[28:31], a[64:67]
  buffer_load_dwordx4 v7, s[16:19], s56 offen offset:1024 lds
  v_mfma_f32_16x16x32_bf16 a[68:71], v[76:79], v[32:35], a[68:71]
  buffer_load_dwordx4 v8, s[16:19], s56 offen offset:2048 lds
  v_mfma_f32_16x16x32_bf16 a[72:75], v[76:79], v[36:39], a[72:75]
  buffer_load_dwordx4 v9, s[16:19], s56 offen offset:3072 lds
  v_mfma_f32_16x16x32_bf16 a[76:79], v[76:79], v[40:43], a[76:79]
  v_mfma_f32_16x16x32_bf16 a[80:83], v[80:83], v[28:31], a[80:83]
  v_mfma_f32_16x16x32_bf16 a[84:87], v[80:83], v[32:35], a[84:87]
  v_mfma_f32_16x16x32_bf16 a[88:91], v[80:83], v[36:39], a[88:91]
  v_mfma_f32_16x16x32_bf16 a[92:95], v[80:83], v[40:43], a[92:95]
  v_mfma_f32_16x16x32_bf16 a[96:99], v[84:87], v[28:31], a[96:99]
  v_mfma_f32_16x16x32_bf16 a[100:103], v[84:87], v[32:35], a[100:103]
  v_mfma_f32_16x16x32_bf16 a[104:107], v[84:87], v[36:39], a[104:107]
  v_mfma_f32_16x16x32_bf16 a[108:111], v[84:87], v[40:43], a[108:111]
  s_waitcnt vmcnt(15)
  s_waitcnt lgkmcnt(0)
  v_mfma_f32_16x16x32_bf16 a[0:3], v[88:91], v[44:47], a[0:3]
  ds_read_b128 v[28:31], v12 offset:8192
  v_mfma_f32_16x16x32_bf16 a[4:7], v[88:91], v[48:51], a[4:7]
  ds_read_b128 v[32:35], v13 offset:8192
  v_mfma_f32_16x16x32_bf16 a[8:11], v[88:91], v[52:55], a[8:11]
  ds_read_b128 v[36:39], v14 offset:8192
  v_mfma_f32_16x16x32_bf16 a[12:15], v[88:91], v[56:59], a[12:15]
  ds_read_b128 v[40:43], v15 offset:8192
  v_mfma_f32_16x16x32_bf16 a[16:19], v[92:95], v[44:47], a[16:19]
  s_add_u32 s57, s55, 64512
  buffer_load_dwordx4 v[60:63], v10, s[20:23], s57 offen offset:0 sc1
  v_mfma_f32_16x16x32_bf16 a[20:23], v[92:95], v[48:51], a[20:23]
  buffer_load_dwordx4 v[64:67], v10, s[20:23], s57 offen offset:1024 sc1
  v_mfma_f32_16x16x32_bf16 a[24:27], v[92:95], v[52:55], a[24:27]
  buffer_load_dwordx4 v[68:71], v10, s[20:23], s57 offen offset:2048 sc1
  v_mfma_f32_16x16x32_bf16 a[28:31], v[92:95], v[56:59], a[28:31]
  buffer_load_dwordx4 v[72:75], v10, s[20:23], s57 offen offset:3072 sc1
  v_mfma_f32_16x16x32_bf16 a[32:35], v[96:99], v[44:47], a[32:35]
  buffer_load_dwordx4 v[76:79], v11, s[20:23], s57 offen offset:0 sc1
  v_mfma_f32_16x16x32_bf16 a[36:39], v[96:99], v[48:51], a[36:39]
  buffer_load_dwordx4 v[80:83], v11, s[20:23], s57 offen offset:1024 sc1
  v_mfma_f32_16x16x32_bf16 a[40:43], v[96:99], v[52:55], a[40:43]
  buffer_load_dwordx4 v[84:87], v11, s[20:23], s57 offen offset:2048 sc1
  v_mfma_f32_16x16x32_bf16 a[44:47], v[96:99], v[56:59], a[44:47]
  v_mfma_f32_16x16x32_bf16 a[48:51], v[100:103], v[44:47], a[48:51]
  v_mfma_f32_16x16x32_bf16 a[52:55], v[100:103], v[48:51], a[52:55]
  v_mfma_f32_16x16x32_bf16 a[56:59], v[100:103], v[52:55], a[56:59]
  v_mfma_f32_16x16x32_bf16 a[60:63], v[100:103], v[56:59], a[60:63]
  v_mfma_f32_16x16x32_bf16 a[64:67], v[104:107], v[44:47], a[64:67]
  v_mfma_f32_16x16x32_bf16 a[68:71], v[104:107], v[48:51], a[68:71]
  v_mfma_f32_16x16x32_bf16 a[72:75], v[104:107], v[52:55], a[72:75]
  v_mfma_f32_16x16x32_bf16 a[76:79], v[104:107], v[56:59], a[76:79]
  v_mfma_f32_16x16x32_bf16 a[80:83], v[108:111], v[44:47], a[80:83]
  v_mfma_f32_16x16x32_bf16 a[84:87], v[108:111], v[48:51], a[84:87]
  v_mfma_f32_16x16x32_bf16 a[88:91], v[108:111], v[52:55], a[88:91]
  v_mfma_f32_16x16x32_bf16 a[92:95], v[108:111], v[56:59], a[92:95]
  v_mfma_f32_16x16x32_bf16 a[96:99], v[112:115], v[44:47], a[96:99]
  v_mfma_f32_16x16x32_bf16 a[100:103], v[112:115], v[48:51], a[100:103]
  v_mfma_f32_16x16x32_bf16 a[104:107], v[112:115], v[52:55], a[104:107]
  v_mfma_f32_16x16x32_bf16 a[108:111], v[112:115], v[56:59], a[108:111]
  s_waitcnt vmcnt(15)
  s_waitcnt lgkmcnt(0)
  v_mfma_f32_16x16x32_bf16 a[0:3], v[116:119], v[28:31], a[0:3]
  ds_read_b128 v[44:47], v16 offset:8192
  v_mfma_f32_16x16x32_bf16 a[4:7], v[116:119], v[32:35], a[4:7]
  ds_read_b128 v[48:51], v17 offset:8192
  v_mfma_f32_16x16x32_bf16 a[8:11], v[116:119], v[36:39], a[8:11]
  ds_read_b128 v[52:55], v18 offset:8192
  v_mfma_f32_16x16x32_bf16 a[12:15], v[116:119], v[40:43], a[12:15]
  ds_read_b128 v[56:59], v19 offset:8192
  v_mfma_f32_16x16x32_bf16 a[16:19], v[120:123], v[28:31], a[16:19]
  s_add_u32 s57, s55, 71680
  buffer_load_dwordx4 v[88:91], v10, s[20:23], s57 offen offset:0 sc1
  v_mfma_f32_16x16x32_bf16 a[20:23], v[120:123], v[32:35], a[20:23]
  buffer_load_dwordx4 v[92:95], v10, s[20:23], s57 offen offset:1024 sc1
  v_mfma_f32_16x16x32_bf16 a[24:27], v[120:123], v[36:39], a[24:27]
  buffer_load_dwordx4 v[96:99], v10, s[20:23], s57 offen offset:2048 sc1
  v_mfma_f32_16x16x32_bf16 a[28:31], v[120:123], v[40:43], a[28:31]
  buffer_load_dwordx4 v[100:103], v10, s[20:23], s57 offen offset:3072 sc1
  v_mfma_f32_16x16x32_bf16 a[32:35], v[124:127], v[28:31], a[32:35]
  buffer_load_dwordx4 v[104:107], v11, s[20:23], s57 offen offset:0 sc1
  v_mfma_f32_16x16x32_bf16 a[36:39], v[124:127], v[32:35], a[36:39]
  buffer_load_dwordx4 v[108:111], v11, s[20:23], s57 offen offset:1024 sc1
  v_mfma_f32_16x16x32_bf16 a[40:43], v[124:127], v[36:39], a[40:43]
  buffer_load_dwordx4 v[112:115], v11, s[20:23], s57 offen offset:2048 sc1
  v_mfma_f32_16x16x32_bf16 a[44:47], v[124:127], v[40:43], a[44:47]
  s_add_u32 m0, s52, 0
  s_add_u32 s56, s54, 768
  buffer_load_dwordx4 v2, s[16:19], s56 offen offset:0 lds
  v_mfma_f32_16x16x32_bf16 a[48:51], v[128:131], v[28:31], a[48:51]
  buffer_load_dwordx4 v3, s[16:19], s56 offen offset:1024 lds
  v_mfma_f32_16x16x32_bf16 a[52:55], v[128:131], v[32:35], a[52:55]
  buffer_load_dwordx4 v4, s[16:19], s56 offen offset:2048 lds
  v_mfma_f32_16x16x32_bf16 a[56:59], v[128:131], v[36:39], a[56:59]
  buffer_load_dwordx4 v5, s[16:19], s56 offen offset:3072 lds
  v_mfma_f32_16x16x32_bf16 a[60:63], v[128:131], v[40:43], a[60:63]
  s_add_u32 m0, s52, 4096
  s_nop 0
  buffer_load_dwordx4 v6, s[16:19], s56 offen offset:0 lds
  v_mfma_f32_16x16x32_bf16 a[64:67], v[132:135], v[28:31], a[64:67]
  buffer_load_dwordx4 v7, s[16:19], s56 offen offset:1024 lds
  v_mfma_f32_16x16x32_bf16 a[68:71], v[132:135], v[32:35], a[68:71]
  buffer_load_dwordx4 v8, s[16:19], s56 offen offset:2048 lds
  v_mfma_f32_16x16x32_bf16 a[72:75], v[132:135], v[36:39], a[72:75]
  buffer_load_dwordx4 v9, s[16:19], s56 offen offset:3072 lds
  v_mfma_f32_16x16x32_bf16 a[76:79], v[132:135], v[40:43], a[76:79]
  v_mfma_f32_16x16x32_bf16 a[80:83], v[136:139], v[28:31], a[80:83]
  v_mfma_f32_16x16x32_bf16 a[84:87], v[136:139], v[32:35], a[84:87]
  v_mfma_f32_16x16x32_bf16 a[88:91], v[136:139], v[36:39], a[88:91]
  v_mfma_f32_16x16x32_bf16 a[92:95], v[136:139], v[40:43], a[92:95]
  v_mfma_f32_16x16x32_bf16 a[96:99], v[140:143], v[28:31], a[96:99]
  v_mfma_f32_16x16x32_bf16 a[100:103], v[140:143], v[32:35], a[100:103]
  v_mfma_f32_16x16x32_bf16 a[104:107], v[140:143], v[36:39], a[104:107]
  v_mfma_f32_16x16x32_bf16 a[108:111], v[140:143], v[40:43], a[108:111]
  s_waitcnt vmcnt(15)
  s_waitcnt lgkmcnt(0)
  v_mfma_f32_16x16x32_bf16 a[0:3], v[60:63], v[44:47], a[0:3]
  ds_read_b128 v[28:31], v12 offset:16384
  v_mfma_f32_16x16x32_bf16 a[4:7], v[60:63], v[48:51], a[4:7]
  ds_read_b128 v[32:35], v13 offset:16384
  v_mfma_f32_16x16x32_bf16 a[8:11], v[60:63], v[52:55], a[8:11]
  ds_read_b128 v[36:39], v14 offset:16384
  v_mfma_f32_16x16x32_bf16 a[12:15], v[60:63], v[56:59], a[12:15]
  ds_read_b128 v[40:43], v15 offset:16384
  v_mfma_f32_16x16x32_bf16 a[16:19], v[64:67], v[44:47], a[16:19]
  s_add_u32 s57, s55, 78848
  buffer_load_dwordx4 v[116:119], v10, s[20:23], s57 offen offset:0 sc1
  v_mfma_f32_16x16x32_bf16 a[20:23], v[64:67], v[48:51], a[20:23]
  buffer_load_dwordx4 v[120:123], v10, s[20:23], s57 offen offset:1024 sc1
  v_mfma_f32_16x16x32_bf16 a[24:27], v[64:67], v[52:55], a[24:27]
  buffer_load_dwordx4 v[124:127], v10, s[20:23], s57 offen offset:2048 sc1
  v_mfma_f32_16x16x32_bf16 a[28:31], v[64:67], v[56:59], a[28:31]
  buffer_load_dwordx4 v[128:131], v10, s[20:23], s57 offen offset:3072 sc1
  v_mfma_f32_16x16x32_bf16 a[32:35], v[68:71], v[44:47], a[32:35]
  buffer_load_dwordx4 v[132:135], v11, s[20:23], s57 offen offset:0 sc1
  v_mfma_f32_16x16x32_bf16 a[36:39], v[68:71], v[48:51], a[36:39]
  buffer_load_dwordx4 v[136:139], v11, s[20:23], s57 offen offset:1024 sc1
  v_mfma_f32_16x16x32_bf16 a[40:43], v[68:71], v[52:55], a[40:43]
  buffer_load_dwordx4 v[140:143], v11, s[20:23], s57 offen offset:2048 sc1
  v_mfma_f32_16x16x32_bf16 a[44:47], v[68:71], v[56:59], a[44:47]
  v_mfma_f32_16x16x32_bf16 a[48:51], v[72:75], v[44:47], a[48:51]
  v_mfma_f32_16x16x32_bf16 a[52:55], v[72:75], v[48:51], a[52:55]
  v_mfma_f32_16x16x32_bf16 a[56:59], v[72:75], v[52:55], a[56:59]
  v_mfma_f32_16x16x32_bf16 a[60:63], v[72:75], v[56:59], a[60:63]
  v_mfma_f32_16x16x32_bf16 a[64:67], v[76:79], v[44:47], a[64:67]
  v_mfma_f32_16x16x32_bf16 a[68:71], v[76:79], v[48:51], a[68:71]
  v_mfma_f32_16x16x32_bf16 a[72:75], v[76:79], v[52:55], a[72:75]
  v_mfma_f32_16x16x32_bf16 a[76:79], v[76:79], v[56:59], a[76:79]
  v_mfma_f32_16x16x32_bf16 a[80:83], v[80:83], v[44:47], a[80:83]
  v_mfma_f32_16x16x32_bf16 a[84:87], v[80:83], v[48:51], a[84:87]
  v_mfma_f32_16x16x32_bf16 a[88:91], v[80:83], v[52:55], a[88:91]
  v_mfma_f32_16x16x32_bf16 a[92:95], v[80:83], v[56:59], a[92:95]
  v_mfma_f32_16x16x32_bf16 a[96:99], v[84:87], v[44:47], a[96:99]
  v_mfma_f32_16x16x32_bf16 a[100:103], v[84:87], v[48:51], a[100:103]
  v_mfma_f32_16x16x32_bf16 a[104:107], v[84:87], v[52:55], a[104:107]
  v_mfma_f32_16x16x32_bf16 a[108:111], v[84:87], v[56:59], a[108:111]
  s_waitcnt vmcnt(15)
  s_waitcnt lgkmcnt(0)
  v_mfma_f32_16x16x32_bf16 a[0:3], v[88:91], v[28:31], a[0:3]
  ds_read_b128 v[44:47], v16 offset:16384
  v_mfma_f32_16x16x32_bf16 a[4:7], v[88:91], v[32:35], a[4:7]
  ds_read_b128 v[48:51], v17 offset:16384
  v_mfma_f32_16x16x32_bf16 a[8:11], v[88:91], v[36:39], a[8:11]
  ds_read_b128 v[52:55], v18 offset:16384
  v_mfma_f32_16x16x32_bf16 a[12:15], v[88:91], v[40:43], a[12:15]
  ds_read_b128 v[56:59], v19 offset:16384
  v_mfma_f32_16x16x32_bf16 a[16:19], v[92:95], v[28:31], a[16:19]
  s_add_u32 s57, s55, 86016
  buffer_load_dwordx4 v[60:63], v10, s[20:23], s57 offen offset:0 sc1
  v_mfma_f32_16x16x32_bf16 a[20:23], v[92:95], v[32:35], a[20:23]
  buffer_load_dwordx4 v[64:67], v10, s[20:23], s57 offen offset:1024 sc1
  v_mfma_f32_16x16x32_bf16 a[24:27], v[92:95], v[36:39], a[24:27]
  buffer_load_dwordx4 v[68:71], v10, s[20:23], s57 offen offset:2048 sc1
  v_mfma_f32_16x16x32_bf16 a[28:31], v[92:95], v[40:43], a[28:31]
  buffer_load_dwordx4 v[72:75], v10, s[20:23], s57 offen offset:3072 sc1
  v_mfma_f32_16x16x32_bf16 a[32:35], v[96:99], v[28:31], a[32:35]
  buffer_load_dwordx4 v[76:79], v11, s[20:23], s57 offen offset:0 sc1
  v_mfma_f32_16x16x32_bf16 a[36:39], v[96:99], v[32:35], a[36:39]
  buffer_load_dwordx4 v[80:83], v11, s[20:23], s57 offen offset:1024 sc1
  v_mfma_f32_16x16x32_bf16 a[40:43], v[96:99], v[36:39], a[40:43]
  buffer_load_dwordx4 v[84:87], v11, s[20:23], s57 offen offset:2048 sc1
  v_mfma_f32_16x16x32_bf16 a[44:47], v[96:99], v[40:43], a[44:47]
  s_add_u32 m0, s52, 8192
  s_add_u32 s56, s54, 896
  buffer_load_dwordx4 v2, s[16:19], s56 offen offset:0 lds
  v_mfma_f32_16x16x32_bf16 a[48:51], v[100:103], v[28:31], a[48:51]
  buffer_load_dwordx4 v3, s[16:19], s56 offen offset:1024 lds
  v_mfma_f32_16x16x32_bf16 a[52:55], v[100:103], v[32:35], a[52:55]
  buffer_load_dwordx4 v4, s[16:19], s56 offen offset:2048 lds
  v_mfma_f32_16x16x32_bf16 a[56:59], v[100:103], v[36:39], a[56:59]
  buffer_load_dwordx4 v5, s[16:19], s56 offen offset:3072 lds
  v_mfma_f32_16x16x32_bf16 a[60:63], v[100:103], v[40:43], a[60:63]
  s_add_u32 m0, s52, 12288
  s_nop 0
  buffer_load_dwordx4 v6, s[16:19], s56 offen offset:0 lds
  v_mfma_f32_16x16x32_bf16 a[64:67], v[104:107], v[28:31], a[64:67]
  buffer_load_dwordx4 v7, s[16:19], s56 offen offset:1024 lds
  v_mfma_f32_16x16x32_bf16 a[68:71], v[104:107], v[32:35], a[68:71]
  buffer_load_dwordx4 v8, s[16:19], s56 offen offset:2048 lds
  v_mfma_f32_16x16x32_bf16 a[72:75], v[104:107], v[36:39], a[72:75]
  buffer_load_dwordx4 v9, s[16:19], s56 offen offset:3072 lds
  v_mfma_f32_16x16x32_bf16 a[76:79], v[104:107], v[40:43], a[76:79]
  v_mfma_f32_16x16x32_bf16 a[80:83], v[108:111], v[28:31], a[80:83]
  v_mfma_f32_16x16x32_bf16 a[84:87], v[108:111], v[32:35], a[84:87]
  v_mfma_f32_16x16x32_bf16 a[88:91], v[108:111], v[36:39], a[88:91]
  v_mfma_f32_16x16x32_bf16 a[92:95], v[108:111], v[40:43], a[92:95]
  v_mfma_f32_16x16x32_bf16 a[96:99], v[112:115], v[28:31], a[96:99]
  v_mfma_f32_16x16x32_bf16 a[100:103], v[112:115], v[32:35], a[100:103]
  v_mfma_f32_16x16x32_bf16 a[104:107], v[112:115], v[36:39], a[104:107]
  v_mfma_f32_16x16x32_bf16 a[108:111], v[112:115], v[40:43], a[108:111]
  s_waitcnt vmcnt(15)
  s_waitcnt lgkmcnt(0)
  v_mfma_f32_16x16x32_bf16 a[0:3], v[116:119], v[44:47], a[0:3]
  ds_read_b128 v[28:31], v12 offset:0
  v_mfma_f32_16x16x32_bf16 a[4:7], v[116:119], v[48:51], a[4:7]
  ds_read_b128 v[32:35], v13 offset:0
  v_mfma_f32_16x16x32_bf16 a[8:11], v[116:119], v[52:55], a[8:11]
  ds_read_b128 v[36:39], v14 offset:0
  v_mfma_f32_16x16x32_bf16 a[12:15], v[116:119], v[56:59], a[12:15]
  ds_read_b128 v[40:43], v15 offset:0
  v_mfma_f32_16x16x32_bf16 a[16:19], v[120:123], v[44:47], a[16:19]
  s_add_u32 s57, s55, 93184
  buffer_load_dwordx4 v[88:91], v10, s[20:23], s57 offen offset:0 sc1
  v_mfma_f32_16x16x32_bf16 a[20:23], v[120:123], v[48:51], a[20:23]
  buffer_load_dwordx4 v[92:95], v10, s[20:23], s57 offen offset:1024 sc1
  v_mfma_f32_16x16x32_bf16 a[24:27], v[120:123], v[52:55], a[24:27]
  buffer_load_dwordx4 v[96:99], v10, s[20:23], s57 offen offset:2048 sc1
  v_mfma_f32_16x16x32_bf16 a[28:31], v[120:123], v[56:59], a[28:31]
  buffer_load_dwordx4 v[100:103], v10, s[20:23], s57 offen offset:3072 sc1
  v_mfma_f32_16x16x32_bf16 a[32:35], v[124:127], v[44:47], a[32:35]
  buffer_load_dwordx4 v[104:107], v11, s[20:23], s57 offen offset:0 sc1
  v_mfma_f32_16x16x32_bf16 a[36:39], v[124:127], v[48:51], a[36:39]
  buffer_load_dwordx4 v[108:111], v11, s[20:23], s57 offen offset:1024 sc1
  v_mfma_f32_16x16x32_bf16 a[40:43], v[124:127], v[52:55], a[40:43]
  buffer_load_dwordx4 v[112:115], v11, s[20:23], s57 offen offset:2048 sc1
  v_mfma_f32_16x16x32_bf16 a[44:47], v[124:127], v[56:59], a[44:47]
  v_mfma_f32_16x16x32_bf16 a[48:51], v[128:131], v[44:47], a[48:51]
  v_mfma_f32_16x16x32_bf16 a[52:55], v[128:131], v[48:51], a[52:55]
  v_mfma_f32_16x16x32_bf16 a[56:59], v[128:131], v[52:55], a[56:59]
  v_mfma_f32_16x16x32_bf16 a[60:63], v[128:131], v[56:59], a[60:63]
  v_mfma_f32_16x16x32_bf16 a[64:67], v[132:135], v[44:47], a[64:67]
  v_mfma_f32_16x16x32_bf16 a[68:71], v[132:135], v[48:51], a[68:71]
  v_mfma_f32_16x16x32_bf16 a[72:75], v[132:135], v[52:55], a[72:75]
  v_mfma_f32_16x16x32_bf16 a[76:79], v[132:135], v[56:59], a[76:79]
  v_mfma_f32_16x16x32_bf16 a[80:83], v[136:139], v[44:47], a[80:83]
  v_mfma_f32_16x16x32_bf16 a[84:87], v[136:139], v[48:51], a[84:87]
  v_mfma_f32_16x16x32_bf16 a[88:91], v[136:139], v[52:55], a[88:91]
  v_mfma_f32_16x16x32_bf16 a[92:95], v[136:139], v[56:59], a[92:95]
  v_mfma_f32_16x16x32_bf16 a[96:99], v[140:143], v[44:47], a[96:99]
  v_mfma_f32_16x16x32_bf16 a[100:103], v[140:143], v[48:51], a[100:103]
  v_mfma_f32_16x16x32_bf16 a[104:107], v[140:143], v[52:55], a[104:107]
  v_mfma_f32_16x16x32_bf16 a[108:111], v[140:143], v[56:59], a[108:111]
  s_waitcnt vmcnt(15)
  s_waitcnt lgkmcnt(0)
  v_mfma_f32_16x16x32_bf16 a[0:3], v[60:63], v[28:31], a[0:3]
  ds_read_b128 v[44:47], v16 offset:0
  v_mfma_f32_16x16x32_bf16 a[4:7], v[60:63], v[32:35], a[4:7]
  ds_read_b128 v[48:51], v17 offset:0
  v_mfma_f32_16x16x32_bf16 a[8:11], v[60:63], v[36:39], a[8:11]
  ds_read_b128 v[52:55], v18 offset:0
  v_mfma_f32_16x16x32_bf16 a[12:15], v[60:63], v[40:43], a[12:15]
  ds_read_b128 v[56:59], v19 offset:0
  v_mfma_f32_16x16x32_bf16 a[16:19], v[64:67], v[28:31], a[16:19]
  s_add_u32 s57, s55, 100352
  buffer_load_dwordx4 v[116:119], v10, s[20:23], s57 offen offset:0 sc1
  v_mfma_f32_16x16x32_bf16 a[20:23], v[64:67], v[32:35], a[20:23]
  buffer_load_dwordx4 v[120:123], v10, s[20:23], s57 offen offset:1024 sc1
  v_mfma_f32_16x16x32_bf16 a[24:27], v[64:67], v[36:39], a[24:27]
  buffer_load_dwordx4 v[124:127], v10, s[20:23], s57 offen offset:2048 sc1
  v_mfma_f32_16x16x32_bf16 a[28:31], v[64:67], v[40:43], a[28:31]
  buffer_load_dwordx4 v[128:131], v10, s[20:23], s57 offen offset:3072 sc1
  v_mfma_f32_16x16x32_bf16 a[32:35], v[68:71], v[28:31], a[32:35]
  buffer_load_dwordx4 v[132:135], v11, s[20:23], s57 offen offset:0 sc1
  v_mfma_f32_16x16x32_bf16 a[36:39], v[68:71], v[32:35], a[36:39]
  buffer_load_dwordx4 v[136:139], v11, s[20:23], s57 offen offset:1024 sc1
  v_mfma_f32_16x16x32_bf16 a[40:43], v[68:71], v[36:39], a[40:43]
  buffer_load_dwordx4 v[140:143], v11, s[20:23], s57 offen offset:2048 sc1
  v_mfma_f32_16x16x32_bf16 a[44:47], v[68:71], v[40:43], a[44:47]
  v_mfma_f32_16x16x32_bf16 a[48:51], v[72:75], v[28:31], a[48:51]
  v_mfma_f32_16x16x32_bf16 a[52:55], v[72:75], v[32:35], a[52:55]
  v_mfma_f32_16x16x32_bf16 a[56:59], v[72:75], v[36:39], a[56:59]
  v_mfma_f32_16x16x32_bf16 a[60:63], v[72:75], v[40:43], a[60:63]
  v_mfma_f32_16x16x32_bf16 a[64:67], v[76:79], v[28:31], a[64:67]
  v_mfma_f32_16x16x32_bf16 a[68:71], v[76:79], v[32:35], a[68:71]
  v_mfma_f32_16x16x32_bf16 a[72:75], v[76:79], v[36:39], a[72:75]
  v_mfma_f32_16x16x32_bf16 a[76:79], v[76:79], v[40:43], a[76:79]
  v_mfma_f32_16x16x32_bf16 a[80:83], v[80:83], v[28:31], a[80:83]
  v_mfma_f32_16x16x32_bf16 a[84:87], v[80:83], v[32:35], a[84:87]
  v_mfma_f32_16x16x32_bf16 a[88:91], v[80:83], v[36:39], a[88:91]
  v_mfma_f32_16x16x32_bf16 a[92:95], v[80:83], v[40:43], a[92:95]
  v_mfma_f32_16x16x32_bf16 a[96:99], v[84:87], v[28:31], a[96:99]
  v_mfma_f32_16x16x32_bf16 a[100:103], v[84:87], v[32:35], a[100:103]
  v_mfma_f32_16x16x32_bf16 a[104:107], v[84:87], v[36:39], a[104:107]
  v_mfma_f32_16x16x32_bf16 a[108:111], v[84:87], v[40:43], a[108:111]
  s_waitcnt vmcnt(7)
  s_waitcnt lgkmcnt(0)
  v_mfma_f32_16x16x32_bf16 a[0:3], v[88:91], v[44:47], a[0:3]
  ds_read_b128 v[28:31], v12 offset:8192
  v_mfma_f32_16x16x32_bf16 a[4:7], v[88:91], v[48:51], a[4:7]
  ds_read_b128 v[32:35], v13 offset:8192
  v_mfma_f32_16x16x32_bf16 a[8:11], v[88:91], v[52:55], a[8:11]
  ds_read_b128 v[36:39], v14 offset:8192
  v_mfma_f32_16x16x32_bf16 a[12:15], v[88:91], v[56:59], a[12:15]
  ds_read_b128 v[40:43], v15 offset:8192
  v_mfma_f32_16x16x32_bf16 a[16:19], v[92:95], v[44:47], a[16:19]
  s_add_u32 s57, s55, 107520
  buffer_load_dwordx4 v[60:63], v10, s[20:23], s57 offen offset:0 sc1
  v_mfma_f32_16x16x32_bf16 a[20:23], v[92:95], v[48:51], a[20:23]
  buffer_load_dwordx4 v[64:67], v10, s[20:23], s57 offen offset:1024 sc1
  v_mfma_f32_16x16x32_bf16 a[24:27], v[92:95], v[52:55], a[24:27]
  buffer_load_dwordx4 v[68:71], v10, s[20:23], s57 offen offset:2048 sc1
  v_mfma_f32_16x16x32_bf16 a[28:31], v[92:95], v[56:59], a[28:31]
  buffer_load_dwordx4 v[72:75], v10, s[20:23], s57 offen offset:3072 sc1
  v_mfma_f32_16x16x32_bf16 a[32:35], v[96:99], v[44:47], a[32:35]
  buffer_load_dwordx4 v[76:79], v11, s[20:23], s57 offen offset:0 sc1
  v_mfma_f32_16x16x32_bf16 a[36:39], v[96:99], v[48:51], a[36:39]
  buffer_load_dwordx4 v[80:83], v11, s[20:23], s57 offen offset:1024 sc1
  v_mfma_f32_16x16x32_bf16 a[40:43], v[96:99], v[52:55], a[40:43]
  buffer_load_dwordx4 v[84:87], v11, s[20:23], s57 offen offset:2048 sc1
  v_mfma_f32_16x16x32_bf16 a[44:47], v[96:99], v[56:59], a[44:47]
  v_mfma_f32_16x16x32_bf16 a[48:51], v[100:103], v[44:47], a[48:51]
  v_mfma_f32_16x16x32_bf16 a[52:55], v[100:103], v[48:51], a[52:55]
  v_mfma_f32_16x16x32_bf16 a[56:59], v[100:103], v[52:55], a[56:59]
  v_mfma_f32_16x16x32_bf16 a[60:63], v[100:103], v[56:59], a[60:63]
  v_mfma_f32_16x16x32_bf16 a[64:67], v[104:107], v[44:47], a[64:67]
  v_mfma_f32_16x16x32_bf16 a[68:71], v[104:107], v[48:51], a[68:71]
  v_mfma_f32_16x16x32_bf16 a[72:75], v[104:107], v[52:55], a[72:75]
  v_mfma_f32_16x16x32_bf16 a[76:79], v[104:107], v[56:59], a[76:79]
  v_mfma_f32_16x16x32_bf16 a[80:83], v[108:111], v[44:47], a[80:83]
  v_mfma_f32_16x16x32_bf16 a[84:87], v[108:111], v[48:51], a[84:87]
  v_mfma_f32_16x16x32_bf16 a[88:91], v[108:111], v[52:55], a[88:91]
  v_mfma_f32_16x16x32_bf16 a[92:95], v[108:111], v[56:59], a[92:95]
  v_mfma_f32_16x16x32_bf16 a[96:99], v[112:115], v[44:47], a[96:99]
  v_mfma_f32_16x16x32_bf16 a[100:103], v[112:115], v[48:51], a[100:103]
  v_mfma_f32_16x16x32_bf16 a[104:107], v[112:115], v[52:55], a[104:107]
  v_mfma_f32_16x16x32_bf16 a[108:111], v[112:115], v[56:59], a[108:111]
  s_waitcnt vmcnt(7)
  s_waitcnt lgkmcnt(0)
  v_mfma_f32_16x16x32_bf16 a[0:3], v[116:119], v[28:31], a[0:3]
  ds_read_b128 v[44:47], v16 offset:8192
  v_mfma_f32_16x16x32_bf16 a[4:7], v[116:119], v[32:35], a[4:7]
  ds_read_b128 v[48:51], v17 offset:8192
  v_mfma_f32_16x16x32_bf16 a[8:11], v[116:119], v[36:39], a[8:11]
  ds_read_b128 v[52:55], v18 offset:8192
  v_mfma_f32_16x16x32_bf16 a[12:15], v[116:119], v[40:43], a[12:15]
  ds_read_b128 v[56:59], v19 offset:8192
  v_mfma_f32_16x16x32_bf16 a[16:19], v[120:123], v[28:31], a[16:19]
  v_mfma_f32_16x16x32_bf16 a[20:23], v[120:123], v[32:35], a[20:23]
  v_mfma_f32_16x16x32_bf16 a[24:27], v[120:123], v[36:39], a[24:27]
  v_mfma_f32_16x16x32_bf16 a[28:31], v[120:123], v[40:43], a[28:31]
  v_mfma_f32_16x16x32_bf16 a[32:35], v[124:127], v[28:31], a[32:35]
  v_mfma_f32_16x16x32_bf16 a[36:39], v[124:127], v[32:35], a[36:39]
  v_mfma_f32_16x16x32_bf16 a[40:43], v[124:127], v[36:39], a[40:43]
  v_mfma_f32_16x16x32_bf16 a[44:47], v[124:127], v[40:43], a[44:47]
  v_mfma_f32_16x16x32_bf16 a[48:51], v[128:131], v[28:31], a[48:51]
  v_mfma_f32_16x16x32_bf16 a[52:55], v[128:131], v[32:35], a[52:55]
  v_mfma_f32_16x16x32_bf16 a[56:59], v[128:131], v[36:39], a[56:59]
  v_mfma_f32_16x16x32_bf16 a[60:63], v[128:131], v[40:43], a[60:63]
  v_mfma_f32_16x16x32_bf16 a[64:67], v[132:135], v[28:31], a[64:67]
  v_mfma_f32_16x16x32_bf16 a[68:71], v[132:135], v[32:35], a[68:71]
  v_mfma_f32_16x16x32_bf16 a[72:75], v[132:135], v[36:39], a[72:75]
  v_mfma_f32_16x16x32_bf16 a[76:79], v[132:135], v[40:43], a[76:79]
  v_mfma_f32_16x16x32_bf16 a[80:83], v[136:139], v[28:31], a[80:83]
  v_mfma_f32_16x16x32_bf16 a[84:87], v[136:139], v[32:35], a[84:87]
  v_mfma_f32_16x16x32_bf16 a[88:91], v[136:139], v[36:39], a[88:91]
  v_mfma_f32_16x16x32_bf16 a[92:95], v[136:139], v[40:43], a[92:95]
  v_mfma_f32_16x16x32_bf16 a[96:99], v[140:143], v[28:31], a[96:99]
  v_mfma_f32_16x16x32_bf16 a[100:103], v[140:143], v[32:35], a[100:103]
  v_mfma_f32_16x16x32_bf16 a[104:107], v[140:143], v[36:39], a[104:107]
  v_mfma_f32_16x16x32_bf16 a[108:111], v[140:143], v[40:43], a[108:111]
  s_and_b32 s53, s15, 1
  s_mul_i32 s58, s15, 7
  s_add_u32 s58, s58, s53
  s_lshr_b32 s58, s58, 1
  s_lshl_b32 s59, s53, 2
  s_sub_u32 s59, 3, s59
  s_add_u32 s59, s59, s58
  s_mul_i32 s60, s14, 28
  s_add_u32 s58, s58, s60
  s_add_u32 s59, s59, s60
  s_lshl_b32 s58, s58, 2
  s_lshl_b32 s59, s59, 2
  s_add_u32 s58, s58, s3
  s_add_u32 s59, s59, s3
  s_lshl_b32 s58, s58, 10
  s_lshl_b32 s59, s59, 10
  s_lshl_b32 s53, s53, 3
  s_add_u32 s59, s59, s53
  s_add_u32 s60, s58, 8192
  s_lshl_b32 s61, s14, 7
  s_lshl_b32 s53, s3, 5
  s_add_u32 s61, s61, s53
  buffer_load_dwordx4 v[88:91], v10, s[24:27], s58 offen sc1
  buffer_load_dwordx4 v[92:95], v11, s[24:27], s58 offen sc1
  buffer_load_dwordx4 v[96:99], v10, s[24:27], s60 offen sc1
  buffer_load_dwordx2 v[100:101], v10, s[24:27], s59 offen sc1
  v_and_b32 v20, 15, v0
  v_lshlrev_b32 v20, 1, v20
  buffer_load_ushort v23, v20, s[32:35], s61 offen
  s_waitcnt vmcnt(5)
  s_waitcnt lgkmcnt(0)
  v_mfma_f32_16x16x32_bf16 a[0:3], v[60:63], v[44:47], a[0:3]
  v_mfma_f32_16x16x32_bf16 a[4:7], v[60:63], v[48:51], a[4:7]
  v_mfma_f32_16x16x32_bf16 a[8:11], v[60:63], v[52:55], a[8:11]
  v_mfma_f32_16x16x32_bf16 a[12:15], v[60:63], v[56:59], a[12:15]
  v_mfma_f32_16x16x32_bf16 a[16:19], v[64:67], v[44:47], a[16:19]
  v_mfma_f32_16x16x32_bf16 a[20:23], v[64:67], v[48:51], a[20:23]
  v_mfma_f32_16x16x32_bf16 a[24:27], v[64:67], v[52:55], a[24:27]
  v_mfma_f32_16x16x32_bf16 a[28:31], v[64:67], v[56:59], a[28:31]
  v_mfma_f32_16x16x32_bf16 a[32:35], v[68:71], v[44:47], a[32:35]
  v_mfma_f32_16x16x32_bf16 a[36:39], v[68:71], v[48:51], a[36:39]
  v_mfma_f32_16x16x32_bf16 a[40:43], v[68:71], v[52:55], a[40:43]
  v_mfma_f32_16x16x32_bf16 a[44:47], v[68:71], v[56:59], a[44:47]
  v_mfma_f32_16x16x32_bf16 a[48:51], v[72:75], v[44:47], a[48:51]
  v_mfma_f32_16x16x32_bf16 a[52:55], v[72:75], v[48:51], a[52:55]
  v_mfma_f32_16x16x32_bf16 a[56:59], v[72:75], v[52:55], a[56:59]
  v_mfma_f32_16x16x32_bf16 a[60:63], v[72:75], v[56:59], a[60:63]
  v_mfma_f32_16x16x32_bf16 a[64:67], v[76:79], v[44:47], a[64:67]
  v_mfma_f32_16x16x32_bf16 a[68:71], v[76:79], v[48:51], a[68:71]
  v_mfma_f32_16x16x32_bf16 a[72:75], v[76:79], v[52:55], a[72:75]
  v_mfma_f32_16x16x32_bf16 a[76:79], v[76:79], v[56:59], a[76:79]
  v_mfma_f32_16x16x32_bf16 a[80:83], v[80:83], v[44:47], a[80:83]
  v_mfma_f32_16x16x32_bf16 a[84:87], v[80:83], v[48:51], a[84:87]
  v_mfma_f32_16x16x32_bf16 a[88:91], v[80:83], v[52:55], a[88:91]
  v_mfma_f32_16x16x32_bf16 a[92:95], v[80:83], v[56:59], a[92:95]
  v_mfma_f32_16x16x32_bf16 a[96:99], v[84:87], v[44:47], a[96:99]
  v_mfma_f32_16x16x32_bf16 a[100:103], v[84:87], v[48:51], a[100:103]
  v_mfma_f32_16x16x32_bf16 a[104:107], v[84:87], v[52:55], a[104:107]
  v_mfma_f32_16x16x32_bf16 a[108:111], v[84:87], v[56:59], a[108:111]
  v_add_u32 v22, s52, v10
  ds_write_b128 v22, a[4:7] offset:0
  ds_write_b128 v22, a[20:23] offset:1024
  ds_write_b128 v22, a[36:39] offset:2048
  ds_write_b128 v22, a[52:55] offset:3072
  ds_write_b128 v22, a[68:71] offset:4096
  ds_write_b128 v22, a[84:87] offset:5120
  ds_write_b128 v22, a[100:103] offset:6144
  ds_write_b128 v22, a[8:11] offset:7168
  ds_write_b128 v22, a[24:27] offset:8192
  ds_write_b128 v22, a[40:43] offset:9216
  ds_write_b128 v22, a[56:59] offset:10240
  ds_write_b128 v22, a[72:75] offset:11264
  ds_write_b128 v22, a[88:91] offset:12288
  ds_write_b128 v22, a[104:107] offset:13312
  ds_write_b128 v22, a[12:15] offset:14336
  ds_write_b128 v22, a[28:31] offset:15360
  ds_write_b128 v22, a[44:47] offset:16384
  ds_write_b128 v22, a[60:63] offset:17408
  ds_write_b128 v22, a[76:79] offset:18432
  ds_write_b128 v22, a[92:95] offset:19456
  ds_write_b128 v22, a[108:111] offset:20480
  s_mov_b32 s62, 0xffff0000
  v_mov_b32 v24, 140536
  v_mov_b32 v25, 1
  s_waitcnt lgkmcnt(0)
  s_mov_b64 exec, 1
  ds_add_u32 v24, v25
  s_mov_b64 exec, -1
  s_mov_b32 s95, 0
p2_gs:
  ds_read_b32 v25, v24
  s_add_u32 s95, s95, 1
  s_waitcnt lgkmcnt(0)
  v_readfirstlane_b32 s94, v25
  s_cmp_eq_u32 s94, 4
  s_cbranch_scc1 p2_gs_ok
  s_cmp_lt_u32 s95, 0x1000000
  s_cbranch_scc1 p2_gs
p2_gs_ok:
  s_sub_u32 s53, s3, 1
  s_and_b32 s53, s53, 3
  s_mul_i32 s53, s53, 24576
  v_add_u32 v22, s53, v10
  ds_read_b128 v[116:119], v22 offset:0
  ds_read_b128 v[120:123], v22 offset:1024
  ds_read_b128 v[124:127], v22 offset:2048
  ds_read_b128 v[128:131], v22 offset:3072
  ds_read_b128 v[132:135], v22 offset:4096
  ds_read_b128 v[136:139], v22 offset:5120
  ds_read_b128 v[140:143], v22 offset:6144
  s_sub_u32 s53, s3, 2
  s_and_b32 s53, s53, 3
  s_mul_i32 s53, s53, 24576
  v_add_u32 v22, s53, v10
  ds_read_b128 v[60:63], v22 offset:7168
  ds_read_b128 v[64:67], v22 offset:8192
  ds_read_b128 v[68:71], v22 offset:9216
  ds_read_b128 v[72:75], v22 offset:10240
  ds_read_b128 v[76:79], v22 offset:11264
  ds_read_b128 v[80:83], v22 offset:12288
  ds_read_b128 v[84:87], v22 offset:13312
  s_sub_u32 s53, s3, 3
  s_and_b32 s53, s53, 3
  s_mul_i32 s53, s53, 24576
  v_add_u32 v22, s53, v10
  ds_read_b128 v[28:31], v22 offset:14336
  ds_read_b128 v[32:35], v22 offset:15360
  ds_read_b128 v[36:39], v22 offset:16384
  ds_read_b128 v[40:43], v22 offset:17408
  ds_read_b128 v[44:47], v22 offset:18432
  ds_read_b128 v[48:51], v22 offset:19456
  ds_read_b128 v[52:55], v22 offset:20480
  s_waitcnt lgkmcnt(14)
  v_accvgpr_read_b32 v24, a0
  v_accvgpr_read_b32 v25, a1
  v_accvgpr_read_b32 v26, a2
  v_accvgpr_read_b32 v27, a3
  v_add_f32 v116, v116, v24
  v_add_f32 v117, v117, v25
  v_add_f32 v118, v118, v26
  v_add_f32 v119, v119, v27
  v_accvgpr_read_b32 v24, a16
  v_accvgpr_read_b32 v25, a17
  v_accvgpr_read_b32 v26, a18
  v_accvgpr_read_b32 v27, a19
  v_add_f32 v120, v120, v24
  v_add_f32 v121, v121, v25
  v_add_f32 v122, v122, v26
  v_add_f32 v123, v123, v27
  v_accvgpr_read_b32 v24, a32
  v_accvgpr_read_b32 v25, a33
  v_accvgpr_read_b32 v26, a34
  v_accvgpr_read_b32 v27, a35
  v_add_f32 v124, v124, v24
  v_add_f32 v125, v125, v25
  v_add_f32 v126, v126, v26
  v_add_f32 v127, v127, v27
  v_accvgpr_read_b32 v24, a48
  v_accvgpr_read_b32 v25, a49
  v_accvgpr_read_b32 v26, a50
  v_accvgpr_read_b32 v27, a51
  v_add_f32 v128, v128, v24
  v_add_f32 v129, v129, v25
  v_add_f32 v130, v130, v26
  v_add_f32 v131, v131, v27
  v_accvgpr_read_b32 v24, a64
  v_accvgpr_read_b32 v25, a65
  v_accvgpr_read_b32 v26, a66
  v_accvgpr_read_b32 v27, a67
  v_add_f32 v132, v132, v24
  v_add_f32 v133, v133, v25
  v_add_f32 v134, v134, v26
  v_add_f32 v135, v135, v27
  v_accvgpr_read_b32 v24, a80
  v_accvgpr_read_b32 v25, a81
  v_accvgpr_read_b32 v26, a82
  v_accvgpr_read_b32 v27, a83
  v_add_f32 v136, v136, v24
  v_add_f32 v137, v137, v25
  v_add_f32 v138, v138, v26
  v_add_f32 v139, v139, v27
  v_accvgpr_read_b32 v24, a96
  v_accvgpr_read_b32 v25, a97
  v_accvgpr_read_b32 v26, a98
  v_accvgpr_read_b32 v27, a99
  v_add_f32 v140, v140, v24
  v_add_f32 v141, v141, v25
  v_add_f32 v142, v142, v26
  v_add_f32 v143, v143, v27
  s_waitcnt lgkmcnt(0)
  v_add_f32 v60, v60, v28
  v_add_f32 v61, v61, v29
  v_add_f32 v62, v62, v30
  v_add_f32 v63, v63, v31
  v_add_f32 v64, v64, v32
  v_add_f32 v65, v65, v33
  v_add_f32 v66, v66, v34
  v_add_f32 v67, v67, v35
  v_add_f32 v68, v68, v36
  v_add_f32 v69, v69, v37
  v_add_f32 v70, v70, v38
  v_add_f32 v71, v71, v39
  v_add_f32 v72, v72, v40
  v_add_f32 v73, v73, v41
  v_add_f32 v74, v74, v42
  v_add_f32 v75, v75, v43
  v_add_f32 v76, v76, v44
  v_add_f32 v77, v77, v45
  v_add_f32 v78, v78, v46
  v_add_f32 v79, v79, v47
  v_add_f32 v80, v80, v48
  v_add_f32 v81, v81, v49
  v_add_f32 v82, v82, v50
  v_add_f32 v83, v83, v51
  v_add_f32 v84, v84, v52
  v_add_f32 v85, v85, v53
  v_add_f32 v86, v86, v54
  v_add_f32 v87, v87, v55
  v_add_f32 v116, v116, v60
  v_add_f32 v117, v117, v61
  v_add_f32 v118, v118, v62
  v_add_f32 v119, v119, v63
  v_add_f32 v120, v120, v64
  v_add_f32 v121, v121, v65
  v_add_f32 v122, v122, v66
  v_add_f32 v123, v123, v67
  v_add_f32 v124, v124, v68
  v_add_f32 v125, v125, v69
  v_add_f32 v126, v126, v70
  v_add_f32 v127, v127, v71
  v_add_f32 v128, v128, v72
  v_add_f32 v129, v129, v73
  v_add_f32 v130, v130, v74
  v_add_f32 v131, v131, v75
  v_add_f32 v132, v132, v76
  v_add_f32 v133, v133, v77
  v_add_f32 v134, v134, v78
  v_add_f32 v135, v135, v79
  v_add_f32 v136, v136, v80
  v_add_f32 v137, v137, v81
  v_add_f32 v138, v138, v82
  v_add_f32 v139, v139, v83
  v_add_f32 v140, v140, v84
  v_add_f32 v141, v141, v85
  v_add_f32 v142, v142, v86
  v_add_f32 v143, v143, v87
  s_waitcnt vmcnt(0)
  v_lshlrev_b32 v21, 16, v23
  v_add_f32 v116, v116, v21
  v_add_f32 v117, v117, v21
  v_cvt_pk_bf16_f32 v24, v116, v117
  v_lshlrev_b32 v25, 16, v88
  v_and_b32 v26, s62, v88
  v_lshlrev_b32 v116, 16, v24
  v_and_b32 v117, s62, v24
  v_mul_f32 v116, v116, v25
  v_mul_f32 v117, v117, v26
  v_cvt_pk_bf16_f32 v60, v116, v117
  v_add_f32 v118, v118, v21
  v_add_f32 v119, v119, v21
  v_cvt_pk_bf16_f32 v24, v118, v119
  v_lshlrev_b32 v25, 16, v89
  v_and_b32 v26, s62, v89
  v_lshlrev_b32 v118, 16, v24
  v_and_b32 v119, s62, v24
  v_mul_f32 v118, v118, v25
  v_mul_f32 v119, v119, v26
  v_cvt_pk_bf16_f32 v61, v118, v119
  v_add_f32 v120, v120, v21
  v_add_f32 v121, v121, v21
  v_cvt_pk_bf16_f32 v24, v120, v121
  v_lshlrev_b32 v25, 16, v90
  v_and_b32 v26, s62, v90
  v_lshlrev_b32 v120, 16, v24
  v_and_b32 v121, s62, v24
  v_mul_f32 v120, v120, v25
  v_mul_f32 v121, v121, v26
  v_cvt_pk_bf16_f32 v62, v120, v121
  v_add_f32 v122, v122, v21
  v_add_f32 v123, v123, v21
  v_cvt_pk_bf16_f32 v24, v122, v123
  v_lshlrev_b32 v25, 16, v91
  v_and_b32 v26, s62, v91
  v_lshlrev_b32 v122, 16, v24
  v_and_b32 v123, s62, v24
  v_mul_f32 v122, v122, v25
  v_mul_f32 v123, v123, v26
  v_cvt_pk_bf16_f32 v63, v122, v123
  buffer_store_dwordx4 v[60:63], v10, s[28:31], s58 offen sc1
  v_add_f32 v124, v124, v21
  v_add_f32 v125, v125, v21
  v_cvt_pk_bf16_f32 v24, v124, v125
  v_lshlrev_b32 v25, 16, v92
  v_and_b32 v26, s62, v92
  v_lshlrev_b32 v124, 16, v24
  v_and_b32 v125, s62, v24
  v_mul_f32 v124, v124, v25
  v_mul_f32 v125, v125, v26
  v_cvt_pk_bf16_f32 v64, v124, v125
  v_add_f32 v126, v126, v21
  v_add_f32 v127, v127, v21
  v_cvt_pk_bf16_f32 v24, v126, v127
  v_lshlrev_b32 v25, 16, v93
  v_and_b32 v26, s62, v93
  v_lshlrev_b32 v126, 16, v24
  v_and_b32 v127, s62, v24
  v_mul_f32 v126, v126, v25
  v_mul_f32 v127, v127, v26
  v_cvt_pk_bf16_f32 v65, v126, v127
  v_add_f32 v128, v128, v21
  v_add_f32 v129, v129, v21
  v_cvt_pk_bf16_f32 v24, v128, v129
  v_lshlrev_b32 v25, 16, v94
  v_and_b32 v26, s62, v94
  v_lshlrev_b32 v128, 16, v24
  v_and_b32 v129, s62, v24
  v_mul_f32 v128, v128, v25
  v_mul_f32 v129, v129, v26
  v_cvt_pk_bf16_f32 v66, v128, v129
  v_add_f32 v130, v130, v21
  v_add_f32 v131, v131, v21
  v_cvt_pk_bf16_f32 v24, v130, v131
  v_lshlrev_b32 v25, 16, v95
  v_and_b32 v26, s62, v95
  v_lshlrev_b32 v130, 16, v24
  v_and_b32 v131, s62, v24
  v_mul_f32 v130, v130, v25
  v_mul_f32 v131, v131, v26
  v_cvt_pk_bf16_f32 v67, v130, v131
  buffer_store_dwordx4 v[64:67], v11, s[28:31], s58 offen sc1
  v_add_f32 v132, v132, v21
  v_add_f32 v133, v133, v21
  v_cvt_pk_bf16_f32 v24, v132, v133
  v_lshlrev_b32 v25, 16, v96
  v_and_b32 v26, s62, v96
  v_lshlrev_b32 v132, 16, v24
  v_and_b32 v133, s62, v24
  v_mul_f32 v132, v132, v25
  v_mul_f32 v133, v133, v26
  v_cvt_pk_bf16_f32 v68, v132, v133
  v_add_f32 v134, v134, v21
  v_add_f32 v135, v135, v21
  v_cvt_pk_bf16_f32 v24, v134, v135
  v_lshlrev_b32 v25, 16, v97
  v_and_b32 v26, s62, v97
  v_lshlrev_b32 v134, 16, v24
  v_and_b32 v135, s62, v24
  v_mul_f32 v134, v134, v25
  v_mul_f32 v135, v135, v26
  v_cvt_pk_bf16_f32 v69, v134, v135
  v_add_f32 v136, v136, v21
  v_add_f32 v137, v137, v21
  v_cvt_pk_bf16_f32 v24, v136, v137
  v_lshlrev_b32 v25, 16, v98
  v_and_b32 v26, s62, v98
  v_lshlrev_b32 v136, 16, v24
  v_and_b32 v137, s62, v24
  v_mul_f32 v136, v136, v25
  v_mul_f32 v137, v137, v26
  v_cvt_pk_bf16_f32 v70, v136, v137
  v_add_f32 v138, v138, v21
  v_add_f32 v139, v139, v21
  v_cvt_pk_bf16_f32 v24, v138, v139
  v_lshlrev_b32 v25, 16, v99
  v_and_b32 v26, s62, v99
  v_lshlrev_b32 v138, 16, v24
  v_and_b32 v139, s62, v24
  v_mul_f32 v138, v138, v25
  v_mul_f32 v139, v139, v26
  v_cvt_pk_bf16_f32 v71, v138, v139
  buffer_store_dwordx4 v[68:71], v10, s[28:31], s60 offen sc1
  v_add_f32 v140, v140, v21
  v_add_f32 v141, v141, v21
  v_cvt_pk_bf16_f32 v24, v140, v141
  v_lshlrev_b32 v25, 16, v100
  v_and_b32 v26, s62, v100
  v_lshlrev_b32 v140, 16, v24
  v_and_b32 v141, s62, v24
  v_mul_f32 v140, v140, v25
  v_mul_f32 v141, v141, v26
  v_cvt_pk_bf16_f32 v72, v140, v141
  v_add_f32 v142, v142, v21
  v_add_f32 v143, v143, v21
  v_cvt_pk_bf16_f32 v24, v142, v143
  v_lshlrev_b32 v25, 16, v101
  v_and_b32 v26, s62, v101
  v_lshlrev_b32 v142, 16, v24
  v_and_b32 v143, s62, v24
  v_mul_f32 v142, v142, v25
  v_mul_f32 v143, v143, v26
  v_cvt_pk_bf16_f32 v73, v142, v143
  buffer_store_dwordx2 v[72:73], v10, s[28:31], s59 offen sc1
  v_mov_b32 v24, 154616
  v_mov_b32 v25, 1
  s_lshl_b32 s53, s14, 7
  s_lshl_b32 s56, s15, 3
  s_add_u32 s53, s53, s56
  s_add_u32 s53, s53, 28352512
  v_mov_b32 v2, s53
  v_mov_b32 v4, s96
  v_mov_b32 v5, s97
  s_waitcnt vmcnt(0)
  s_mov_b64 exec, 1
  ds_add_rtn_u32 v25, v24, v25
  s_waitcnt lgkmcnt(0)
  v_readfirstlane_b32 s94, v25
  s_cmp_lg_u32 s94, 3
  s_cbranch_scc1 p2_hn
  global_store_dwordx2 v2, v[4:5], s[8:9] sc0 sc1
p2_hn:
  s_mov_b64 exec, -1
  s_branch p2_done
k2_conv:
  s_sub_u32 s52, s3, 4
  s_lshr_b32 s53, s52, 1
  s_lshl_b32 s54, s2, 1
  s_add_u32 s54, s54, s53
  s_mul_i32 s55, s52, 14080
  s_add_u32 s55, s55, 98304
  s_lshr_b32 s63, s52, 1
  s_mul_i32 s63, s63, 4608
  s_add_u32 s63, s63, 154624
  v_mov_b32 v4, 0
  v_mov_b32 v5, 0
  v_lshlrev_b32 v3, 3, v0
  v_add_u32 v3, s63, v3
  ds_write_b64 v3, v[4:5]
  s_xor_b32 s60, s52, 1
  s_mul_i32 s60, s60, 14080
  s_add_u32 s60, s60, 98304
  s_and_b32 s61, s52, 1
  v_lshlrev_b32 v110, 16, v110
  v_lshlrev_b32 v17, 2, v0
  v_add_u32 v17, s55, v17
  v_and_b32 v2, 31, v0
  v_lshrrev_b32 v3, 5, v0
  s_movk_i32 s53, 264
  v_mul_u32_u24 v2, s53, v2
  v_lshl_add_u32 v2, v3, 4, v2
  v_add_u32 v18, s55, v2
  s_mov_b32 s65, 0x3fb8aa3b
  s_mov_b32 s66, 0x3e22f983
  s_lshl_b32 s56, s61, 4
  s_sub_u32 s58, 16, s56
  s_mov_b32 s84, 0xffff0000
  v_mul_f32 v2, s65, v110
  v_exp_f32 v2, v2
  s_nop 0
  v_cvt_pk_bf16_f32 v3, v2, v2
  v_lshlrev_b32 v2, 16, v3
  v_lshlrev_b32 v4, s58, v104
  v_and_b32 v4, s84, v4
  v_lshlrev_b32 v5, s58, v105
  v_and_b32 v5, s84, v5
  v_mul_f32 v4, v4, v2
  v_mul_f32 v5, v5, v2
  v_mul_f32 v20, s65, v4
  v_mul_f32 v21, s66, v5
  v_lshlrev_b32 v4, s58, v106
  v_and_b32 v4, s84, v4
  v_lshlrev_b32 v5, s58, v107
  v_and_b32 v5, s84, v5
  v_mul_f32 v4, v4, v2
  v_mul_f32 v5, v5, v2
  v_lshlrev_b32 v6, s58, v108
  v_and_b32 v6, s84, v6
  v_lshlrev_b32 v7, s58, v109
  v_and_b32 v7, s84, v7
  v_mul_f32 v22, v4, v6
  v_mul_f32 v23, v4, v7
  v_fma_f32 v22, -v5, v7, v22
  v_fmac_f32 v23, v5, v6
  v_lshlrev_b32 v4, s56, v106
  v_and_b32 v4, s84, v4
  v_lshlrev_b32 v5, s56, v107
  v_and_b32 v5, s84, v5
  v_mul_f32 v4, v4, v2
  v_mul_f32 v5, v5, v2
  v_lshlrev_b32 v6, s56, v108
  v_and_b32 v6, s84, v6
  v_lshlrev_b32 v7, s56, v109
  v_and_b32 v7, s84, v7
  v_mul_f32 v24, v4, v6
  v_mul_f32 v25, v4, v7
  v_fma_f32 v24, -v5, v7, v24
  v_fmac_f32 v25, v5, v6
  v_max3_f32 v2, abs(v22), abs(v23), abs(v24)
  v_max_f32 v2, abs(v25), v2
  v_exp_f32 v4, v20
  v_fract_f32 v5, v21
  v_cos_f32 v26, v5
  v_sin_f32 v27, v5
  v_mul_f32 v26, v26, v4
  v_mul_f32 v27, v27, v4
  v_max_f32_dpp v2, v2, v2 quad_perm:[1,0,3,2] row_mask:0xf bank_mask:0xf
  v_mul_f32 v6, 0x41000000, v20
  v_mul_f32 v7, 0x41000000, v21
  v_exp_f32 v6, v6
  v_fract_f32 v7, v7
  v_cos_f32 v28, v7
  v_sin_f32 v29, v7
  v_mul_f32 v28, v28, v6
  v_mul_f32 v29, v29, v6
  v_max_f32_dpp v2, v2, v2 quad_perm:[2,3,0,1] row_mask:0xf bank_mask:0xf
  v_mul_f32 v4, 0x42800000, v20
  v_mul_f32 v5, 0x42800000, v21
  v_exp_f32 v4, v4
  v_fract_f32 v5, v5
  v_cos_f32 v30, v5
  v_sin_f32 v31, v5
  v_mul_f32 v30, v30, v4
  v_mul_f32 v31, v31, v4
  v_max_f32_dpp v2, v2, v2 row_half_mirror row_mask:0xf bank_mask:0xf
  v_mul_f32 v6, 0x43800000, v20
  v_mul_f32 v7, 0x43800000, v21
  v_exp_f32 v6, v6
  v_fract_f32 v7, v7
  v_cos_f32 v32, v7
  v_sin_f32 v33, v7
  v_mul_f32 v32, v32, v6
  v_mul_f32 v33, v33, v6
  v_max_f32_dpp v2, v2, v2 row_mirror row_mask:0xf bank_mask:0xf
  v_mul_f32 v4, 0x44800000, v20
  v_mul_f32 v5, 0x44800000, v21
  v_exp_f32 v4, v4
  v_fract_f32 v5, v5
  v_cos_f32 v34, v5
  v_sin_f32 v35, v5
  v_mul_f32 v34, v34, v4
  v_mul_f32 v35, v35, v4
  v_readlane_b32 s84, v2, 0
  v_readlane_b32 s56, v2, 16
  v_readlane_b32 s57, v2, 32
  v_readlane_b32 s58, v2, 48
  s_max_u32 s84, s84, s56
  s_max_u32 s57, s57, s58
  s_max_u32 s84, s84, s57
  s_lshr_b32 s84, s84, 23
  s_max_u32 s84, s84, 6
  s_min_u32 s84, s84, 250
  s_sub_u32 s56, 259, s84
  s_lshl_b32 s56, s56, 23
  s_sub_u32 s57, s84, 5
  s_lshl_b32 s57, s57, 23
  v_mul_f32 v22, s56, v22
  v_mul_f32 v23, s56, v23
  v_cvt_pk_f16_f32 v52, v22, -v23
  ds_write_b32 v17, v52 offset:0
  v_mov_b32 v56, 0x3c00
  ds_write_b32 v17, v56 offset:5544
  v_cvt_pk_f16_f32 v81, v26, v27
  v_cvt_pk_f16_f32 v89, v28, v29
  ds_write_b32 v17, v89 offset:5808
  v_cvt_pk_f16_f32 v53, v30, v31
  ds_write_b32 v17, v53 offset:7656
  v_mul_f32 v36, v26, v26
  v_mul_f32 v37, v26, v27
  v_fma_f32 v36, -v27, v27, v36
  v_fmac_f32 v37, v27, v26
  v_mul_f32 v40, v28, v28
  v_mul_f32 v41, v28, v29
  v_fma_f32 v40, -v29, v29, v40
  v_fmac_f32 v41, v29, v28
  v_cvt_pk_f16_f32 v82, v36, v37
  v_cvt_pk_f16_f32 v90, v40, v41
  ds_write_b32 v17, v90 offset:6072
  v_mul_f32 v38, v36, v26
  v_mul_f32 v39, v36, v27
  v_fma_f32 v38, -v37, v27, v38
  v_fmac_f32 v39, v37, v26
  v_mul_f32 v42, v40, v28
  v_mul_f32 v43, v40, v29
  v_fma_f32 v42, -v41, v29, v42
  v_fmac_f32 v43, v41, v28
  v_cvt_pk_f16_f32 v83, v38, v39
  v_cvt_pk_f16_f32 v91, v42, v43
  ds_write_b32 v17, v91 offset:6336
  v_mul_f32 v36, v38, v26
  v_mul_f32 v37, v38, v27
  v_fma_f32 v36, -v39, v27, v36
  v_fmac_f32 v37, v39, v26
  v_mul_f32 v40, v42, v28
  v_mul_f32 v41, v42, v29
  v_fma_f32 v40, -v43, v29, v40
  v_fmac_f32 v41, v43, v28
  v_cvt_pk_f16_f32 v84, v36, v37
  v_cvt_pk_f16_f32 v92, v40, v41
  ds_write_b32 v17, v92 offset:6600
  v_mul_f32 v38, v36, v26
  v_mul_f32 v39, v36, v27
  v_fma_f32 v38, -v37, v27, v38
  v_fmac_f32 v39, v37, v26
  v_mul_f32 v42, v40, v28
  v_mul_f32 v43, v40, v29
  v_fma_f32 v42, -v41, v29, v42
  v_fmac_f32 v43, v41, v28
  v_cvt_pk_f16_f32 v85, v38, v39
  v_cvt_pk_f16_f32 v93, v42, v43
  ds_write_b32 v17, v93 offset:6864
  v_mul_f32 v36, v38, v26
  v_mul_f32 v37, v38, v27
  v_fma_f32 v36, -v39, v27, v36
  v_fmac_f32 v37, v39, v26
  v_mul_f32 v40, v42, v28
  v_mul_f32 v41, v42, v29
  v_fma_f32 v40, -v43, v29, v40
  v_fmac_f32 v41, v43, v28
  v_cvt_pk_f16_f32 v86, v36, v37
  v_cvt_pk_f16_f32 v94, v40, v41
  ds_write_b32 v17, v94 offset:7128
  v_mul_f32 v38, v36, v26
  v_mul_f32 v39, v36, v27
  v_fma_f32 v38, -v37, v27, v38
  v_fmac_f32 v39, v37, v26
  v_mul_f32 v42, v40, v28
  v_mul_f32 v43, v40, v29
  v_fma_f32 v42, -v41, v29, v42
  v_fmac_f32 v43, v41, v28
  v_cvt_pk_f16_f32 v87, v38, v39
  v_cvt_pk_f16_f32 v95, v42, v43
  ds_write_b32 v17, v95 offset:7392
  v_mul_f32 v48, v30, v30
  v_mul_f32 v49, v30, v31
  v_fma_f32 v48, -v31, v31, v48
  v_fmac_f32 v49, v31, v30
  v_mul_f32 v44, v32, v32
  v_mul_f32 v45, v32, v33
  v_fma_f32 v44, -v33, v33, v44
  v_fmac_f32 v45, v33, v32
  v_mul_f32 v50, v48, v30
  v_mul_f32 v51, v48, v31
  v_fma_f32 v50, -v49, v31, v50
  v_fmac_f32 v51, v49, v30
  v_mul_f32 v46, v44, v32
  v_mul_f32 v47, v44, v33
  v_fma_f32 v46, -v45, v33, v46
  v_fmac_f32 v47, v45, v32
  v_cvt_pk_f16_f32 v54, v48, v49
  ds_write_b32 v17, v54 offset:9768
  v_cvt_pk_f16_f32 v55, v50, v51
  ds_write_b32 v17, v55 offset:11880
  v_pk_mul_f16 v61, v89, v53 op_sel:[0,0] op_sel_hi:[1,0] neg_hi:[0,0]
  s_nop 0
  v_pk_fma_f16 v57, v89, v53, v61 op_sel:[1,1,0] op_sel_hi:[0,1,1] neg_lo:[1,0,0] neg_hi:[0,0,0]
  ds_write_b32 v17, v57 offset:7920
  v_pk_mul_f16 v60, v90, v53 op_sel:[0,0] op_sel_hi:[1,0] neg_hi:[0,0]
  s_nop 0
  v_pk_fma_f16 v58, v90, v53, v60 op_sel:[1,1,0] op_sel_hi:[0,1,1] neg_lo:[1,0,0] neg_hi:[0,0,0]
  ds_write_b32 v17, v58 offset:8184
  v_pk_mul_f16 v61, v91, v53 op_sel:[0,0] op_sel_hi:[1,0] neg_hi:[0,0]
  s_nop 0
  v_pk_fma_f16 v59, v91, v53, v61 op_sel:[1,1,0] op_sel_hi:[0,1,1] neg_lo:[1,0,0] neg_hi:[0,0,0]
  ds_write_b32 v17, v59 offset:8448
  v_pk_mul_f16 v60, v92, v53 op_sel:[0,0] op_sel_hi:[1,0] neg_hi:[0,0]
  s_nop 0
  v_pk_fma_f16 v56, v92, v53, v60 op_sel:[1,1,0] op_sel_hi:[0,1,1] neg_lo:[1,0,0] neg_hi:[0,0,0]
  ds_write_b32 v17, v56 offset:8712
  v_pk_mul_f16 v61, v93, v53 op_sel:[0,0] op_sel_hi:[1,0] neg_hi:[0,0]
  s_nop 0
  v_pk_fma_f16 v57, v93, v53, v61 op_sel:[1,1,0] op_sel_hi:[0,1,1] neg_lo:[1,0,0] neg_hi:[0,0,0]
  ds_write_b32 v17, v57 offset:8976
  v_pk_mul_f16 v60, v94, v53 op_sel:[0,0] op_sel_hi:[1,0] neg_hi:[0,0]
  s_nop 0
  v_pk_fma_f16 v58, v94, v53, v60 op_sel:[1,1,0] op_sel_hi:[0,1,1] neg_lo:[1,0,0] neg_hi:[0,0,0]
  ds_write_b32 v17, v58 offset:9240
  v_pk_mul_f16 v61, v95, v53 op_sel:[0,0] op_sel_hi:[1,0] neg_hi:[0,0]
  s_nop 0
  v_pk_fma_f16 v59, v95, v53, v61 op_sel:[1,1,0] op_sel_hi:[0,1,1] neg_lo:[1,0,0] neg_hi:[0,0,0]
  ds_write_b32 v17, v59 offset:9504
  v_pk_mul_f16 v61, v89, v54 op_sel:[0,0] op_sel_hi:[1,0] neg_hi:[0,0]
  s_nop 0
  v_pk_fma_f16 v57, v89, v54, v61 op_sel:[1,1,0] op_sel_hi:[0,1,1] neg_lo:[1,0,0] neg_hi:[0,0,0]
  ds_write_b32 v17, v57 offset:10032
  v_pk_mul_f16 v60, v90, v54 op_sel:[0,0] op_sel_hi:[1,0] neg_hi:[0,0]
  s_nop 0
  v_pk_fma_f16 v58, v90, v54, v60 op_sel:[1,1,0] op_sel_hi:[0,1,1] neg_lo:[1,0,0] neg_hi:[0,0,0]
  ds_write_b32 v17, v58 offset:10296
  v_pk_mul_f16 v61, v91, v54 op_sel:[0,0] op_sel_hi:[1,0] neg_hi:[0,0]
  s_nop 0
  v_pk_fma_f16 v59, v91, v54, v61 op_sel:[1,1,0] op_sel_hi:[0,1,1] neg_lo:[1,0,0] neg_hi:[0,0,0]
  ds_write_b32 v17, v59 offset:10560
  v_pk_mul_f16 v60, v92, v54 op_sel:[0,0] op_sel_hi:[1,0] neg_hi:[0,0]
  s_nop 0
  v_pk_fma_f16 v56, v92, v54, v60 op_sel:[1,1,0] op_sel_hi:[0,1,1] neg_lo:[1,0,0] neg_hi:[0,0,0]
  ds_write_b32 v17, v56 offset:10824
  v_pk_mul_f16 v61, v93, v54 op_sel:[0,0] op_sel_hi:[1,0] neg_hi:[0,0]
  s_nop 0
  v_pk_fma_f16 v57, v93, v54, v61 op_sel:[1,1,0] op_sel_hi:[0,1,1] neg_lo:[1,0,0] neg_hi:[0,0,0]
  ds_write_b32 v17, v57 offset:11088
  v_pk_mul_f16 v60, v94, v54 op_sel:[0,0] op_sel_hi:[1,0] neg_hi:[0,0]
  s_nop 0
  v_pk_fma_f16 v58, v94, v54, v60 op_sel:[1,1,0] op_sel_hi:[0,1,1] neg_lo:[1,0,0] neg_hi:[0,0,0]
  ds_write_b32 v17, v58 offset:11352
  v_pk_mul_f16 v61, v95, v54 op_sel:[0,0] op_sel_hi:[1,0] neg_hi:[0,0]
  s_nop 0
  v_pk_fma_f16 v59, v95, v54, v61 op_sel:[1,1,0] op_sel_hi:[0,1,1] neg_lo:[1,0,0] neg_hi:[0,0,0]
  ds_write_b32 v17, v59 offset:11616
  v_pk_mul_f16 v61, v89, v55 op_sel:[0,0] op_sel_hi:[1,0] neg_hi:[0,0]
  s_nop 0
  v_pk_fma_f16 v57, v89, v55, v61 op_sel:[1,1,0] op_sel_hi:[0,1,1] neg_lo:[1,0,0] neg_hi:[0,0,0]
  ds_write_b32 v17, v57 offset:12144
  v_pk_mul_f16 v60, v90, v55 op_sel:[0,0] op_sel_hi:[1,0] neg_hi:[0,0]
  s_nop 0
  v_pk_fma_f16 v58, v90, v55, v60 op_sel:[1,1,0] op_sel_hi:[0,1,1] neg_lo:[1,0,0] neg_hi:[0,0,0]
  ds_write_b32 v17, v58 offset:12408
  v_pk_mul_f16 v61, v91, v55 op_sel:[0,0] op_sel_hi:[1,0] neg_hi:[0,0]
  s_nop 0
  v_pk_fma_f16 v59, v91, v55, v61 op_sel:[1,1,0] op_sel_hi:[0,1,1] neg_lo:[1,0,0] neg_hi:[0,0,0]
  ds_write_b32 v17, v59 offset:12672
  v_pk_mul_f16 v60, v92, v55 op_sel:[0,0] op_sel_hi:[1,0] neg_hi:[0,0]
  s_nop 0
  v_pk_fma_f16 v56, v92, v55, v60 op_sel:[1,1,0] op_sel_hi:[0,1,1] neg_lo:[1,0,0] neg_hi:[0,0,0]
  ds_write_b32 v17, v56 offset:12936
  v_pk_mul_f16 v61, v93, v55 op_sel:[0,0] op_sel_hi:[1,0] neg_hi:[0,0]
  s_nop 0
  v_pk_fma_f16 v57, v93, v55, v61 op_sel:[1,1,0] op_sel_hi:[0,1,1] neg_lo:[1,0,0] neg_hi:[0,0,0]
  ds_write_b32 v17, v57 offset:13200
  v_pk_mul_f16 v60, v94, v55 op_sel:[0,0] op_sel_hi:[1,0] neg_hi:[0,0]
  s_nop 0
  v_pk_fma_f16 v58, v94, v55, v60 op_sel:[1,1,0] op_sel_hi:[0,1,1] neg_lo:[1,0,0] neg_hi:[0,0,0]
  ds_write_b32 v17, v58 offset:13464
  v_pk_mul_f16 v61, v95, v55 op_sel:[0,0] op_sel_hi:[1,0] neg_hi:[0,0]
  s_nop 0
  v_pk_fma_f16 v59, v95, v55, v61 op_sel:[1,1,0] op_sel_hi:[0,1,1] neg_lo:[1,0,0] neg_hi:[0,0,0]
  ds_write_b32 v17, v59 offset:13728
  v_pk_mul_f16 v61, v52, v81 op_sel:[0,0] op_sel_hi:[1,0] neg_hi:[0,0]
  s_nop 0
  v_pk_fma_f16 v57, v52, v81, v61 op_sel:[1,1,0] op_sel_hi:[0,1,1] neg_lo:[0,0,0] neg_hi:[1,0,0]
  ds_write_b32 v17, v57 offset:264
  v_pk_mul_f16 v60, v52, v82 op_sel:[0,0] op_sel_hi:[1,0] neg_hi:[0,0]
  s_nop 0
  v_pk_fma_f16 v58, v52, v82, v60 op_sel:[1,1,0] op_sel_hi:[0,1,1] neg_lo:[0,0,0] neg_hi:[1,0,0]
  ds_write_b32 v17, v58 offset:528
  v_pk_mul_f16 v61, v52, v83 op_sel:[0,0] op_sel_hi:[1,0] neg_hi:[0,0]
  s_nop 0
  v_pk_fma_f16 v59, v52, v83, v61 op_sel:[1,1,0] op_sel_hi:[0,1,1] neg_lo:[0,0,0] neg_hi:[1,0,0]
  ds_write_b32 v17, v59 offset:792
  v_pk_mul_f16 v60, v52, v84 op_sel:[0,0] op_sel_hi:[1,0] neg_hi:[0,0]
  s_nop 0
  v_pk_fma_f16 v56, v52, v84, v60 op_sel:[1,1,0] op_sel_hi:[0,1,1] neg_lo:[0,0,0] neg_hi:[1,0,0]
  ds_write_b32 v17, v56 offset:1056
  v_pk_mul_f16 v61, v52, v85 op_sel:[0,0] op_sel_hi:[1,0] neg_hi:[0,0]
  s_nop 0
  v_pk_fma_f16 v57, v52, v85, v61 op_sel:[1,1,0] op_sel_hi:[0,1,1] neg_lo:[0,0,0] neg_hi:[1,0,0]
  ds_write_b32 v17, v57 offset:1320
  v_pk_mul_f16 v60, v52, v86 op_sel:[0,0] op_sel_hi:[1,0] neg_hi:[0,0]
  s_nop 0
  v_pk_fma_f16 v58, v52, v86, v60 op_sel:[1,1,0] op_sel_hi:[0,1,1] neg_lo:[0,0,0] neg_hi:[1,0,0]
  ds_write_b32 v17, v58 offset:1584
  v_pk_mul_f16 v61, v52, v87 op_sel:[0,0] op_sel_hi:[1,0] neg_hi:[0,0]
  s_nop 0
  v_pk_fma_f16 v59, v52, v87, v61 op_sel:[1,1,0] op_sel_hi:[0,1,1] neg_lo:[0,0,0] neg_hi:[1,0,0]
  ds_write_b32 v17, v59 offset:1848
  v_mul_f32 v48, v32, v22
  v_mul_f32 v49, v32, v23
  v_fma_f32 v48, -v33, v23, v48
  v_fmac_f32 v49, v33, v22
  v_cvt_pk_f16_f32 v62, v48, -v49
  ds_write_b32 v17, v62 offset:2112
  v_pk_mul_f16 v60, v62, v82 op_sel:[0,0] op_sel_hi:[1,0] neg_hi:[0,0]
  s_nop 0
  v_pk_fma_f16 v56, v62, v82, v60 op_sel:[1,1,0] op_sel_hi:[0,1,1] neg_lo:[0,0,0] neg_hi:[1,0,0]
  ds_write_b32 v17, v56 offset:2376
  v_pk_mul_f16 v61, v62, v84 op_sel:[0,0] op_sel_hi:[1,0] neg_hi:[0,0]
  s_nop 0
  v_pk_fma_f16 v57, v62, v84, v61 op_sel:[1,1,0] op_sel_hi:[0,1,1] neg_lo:[0,0,0] neg_hi:[1,0,0]
  ds_write_b32 v17, v57 offset:2640
  v_pk_mul_f16 v60, v62, v86 op_sel:[0,0] op_sel_hi:[1,0] neg_hi:[0,0]
  s_nop 0
  v_pk_fma_f16 v58, v62, v86, v60 op_sel:[1,1,0] op_sel_hi:[0,1,1] neg_lo:[0,0,0] neg_hi:[1,0,0]
  ds_write_b32 v17, v58 offset:2904
  v_mul_f32 v50, v44, v22
  v_mul_f32 v51, v44, v23
  v_fma_f32 v50, -v45, v23, v50
  v_fmac_f32 v51, v45, v22
  v_cvt_pk_f16_f32 v62, v50, -v51
  ds_write_b32 v17, v62 offset:3168
  v_pk_mul_f16 v60, v62, v84 op_sel:[0,0] op_sel_hi:[1,0] neg_hi:[0,0]
  s_nop 0
  v_pk_fma_f16 v56, v62, v84, v60 op_sel:[1,1,0] op_sel_hi:[0,1,1] neg_lo:[0,0,0] neg_hi:[1,0,0]
  ds_write_b32 v17, v56 offset:3432
  v_mul_f32 v48, v46, v22
  v_mul_f32 v49, v46, v23
  v_fma_f32 v48, -v47, v23, v48
  v_fmac_f32 v49, v47, v22
  v_cvt_pk_f16_f32 v62, v48, -v49
  ds_write_b32 v17, v62 offset:3696
  v_pk_mul_f16 v60, v62, v84 op_sel:[0,0] op_sel_hi:[1,0] neg_hi:[0,0]
  s_nop 0
  v_pk_fma_f16 v56, v62, v84, v60 op_sel:[1,1,0] op_sel_hi:[0,1,1] neg_lo:[0,0,0] neg_hi:[1,0,0]
  ds_write_b32 v17, v56 offset:3960
  v_cvt_pk_f16_f32 v63, v34, v35
  v_pk_mul_f16 v60, v52, v63 op_sel:[0,0] op_sel_hi:[1,0] neg_hi:[0,0]
  s_nop 0
  v_pk_fma_f16 v56, v52, v63, v60 op_sel:[1,1,0] op_sel_hi:[0,1,1] neg_lo:[0,0,0] neg_hi:[1,0,0]
  ds_write_b32 v17, v56 offset:4224
  v_mul_f32 v48, v34, v32
  v_mul_f32 v49, v34, v33
  v_fma_f32 v48, -v35, v33, v48
  v_fmac_f32 v49, v35, v32
  v_cvt_pk_f16_f32 v62, v48, v49
  v_pk_mul_f16 v60, v52, v62 op_sel:[0,0] op_sel_hi:[1,0] neg_hi:[0,0]
  s_nop 0
  v_pk_fma_f16 v57, v52, v62, v60 op_sel:[1,1,0] op_sel_hi:[0,1,1] neg_lo:[0,0,0] neg_hi:[1,0,0]
  ds_write_b32 v17, v57 offset:4488
  v_mul_f32 v50, v34, v44
  v_mul_f32 v51, v34, v45
  v_fma_f32 v50, -v35, v45, v50
  v_fmac_f32 v51, v35, v44
  v_cvt_pk_f16_f32 v63, v50, v51
  v_pk_mul_f16 v60, v52, v63 op_sel:[0,0] op_sel_hi:[1,0] neg_hi:[0,0]
  s_nop 0
  v_pk_fma_f16 v58, v52, v63, v60 op_sel:[1,1,0] op_sel_hi:[0,1,1] neg_lo:[0,0,0] neg_hi:[1,0,0]
  ds_write_b32 v17, v58 offset:4752
  v_mul_f32 v48, v34, v46
  v_mul_f32 v49, v34, v47
  v_fma_f32 v48, -v35, v47, v48
  v_fmac_f32 v49, v35, v46
  v_cvt_pk_f16_f32 v62, v48, v49
  v_pk_mul_f16 v60, v52, v62 op_sel:[0,0] op_sel_hi:[1,0] neg_hi:[0,0]
  s_nop 0
  v_pk_fma_f16 v57, v52, v62, v60 op_sel:[1,1,0] op_sel_hi:[0,1,1] neg_lo:[0,0,0] neg_hi:[1,0,0]
  ds_write_b32 v17, v57 offset:5016
  v_mul_f32 v50, v34, v34
  v_mul_f32 v51, v34, v35
  v_fma_f32 v50, -v35, v35, v50
  v_fmac_f32 v51, v35, v34
  v_cvt_pk_f16_f32 v63, v50, v51
  v_pk_mul_f16 v60, v52, v63 op_sel:[0,0] op_sel_hi:[1,0] neg_hi:[0,0]
  s_nop 0
  v_pk_fma_f16 v58, v52, v63, v60 op_sel:[1,1,0] op_sel_hi:[0,1,1] neg_lo:[0,0,0] neg_hi:[1,0,0]
  ds_write_b32 v17, v58 offset:5280
  s_waitcnt lgkmcnt(0)
  ds_read_b64 v[80:81], v18 offset:0
  ds_read_b64 v[84:85], v18 offset:5544
  ds_read_b64 v[82:83], v18 offset:8
  ds_read_b64 v[86:87], v18 offset:5552
  ds_read_b64 v[88:89], v18 offset:32
  ds_read_b64 v[92:93], v18 offset:5576
  ds_read_b64 v[90:91], v18 offset:40
  ds_read_b64 v[94:95], v18 offset:5584
  s_waitcnt lgkmcnt(4)
  v_mfma_f32_32x32x16_f16 v[64:79], v[80:83], v[84:87], 0
  ds_read_b64 v[80:81], v18 offset:64
  ds_read_b64 v[84:85], v18 offset:5608
  ds_read_b64 v[82:83], v18 offset:72
  ds_read_b64 v[86:87], v18 offset:5616
  s_waitcnt lgkmcnt(4)
  v_mfma_f32_32x32x16_f16 v[64:79], v[88:91], v[92:95], v[64:79]
  ds_read_b64 v[88:89], v18 offset:96
  ds_read_b64 v[92:93], v18 offset:5640
  ds_read_b64 v[90:91], v18 offset:104
  ds_read_b64 v[94:95], v18 offset:5648
  s_waitcnt lgkmcnt(4)
  v_mfma_f32_32x32x16_f16 v[64:79], v[80:83], v[84:87], v[64:79]
  ds_read_b64 v[80:81], v18 offset:128
  ds_read_b64 v[84:85], v18 offset:5672
  ds_read_b64 v[82:83], v18 offset:136
  ds_read_b64 v[86:87], v18 offset:5680
  s_waitcnt lgkmcnt(4)
  v_mfma_f32_32x32x16_f16 v[64:79], v[88:91], v[92:95], v[64:79]
  ds_read_b64 v[88:89], v18 offset:160
  ds_read_b64 v[92:93], v18 offset:5704
  ds_read_b64 v[90:91], v18 offset:168
  ds_read_b64 v[94:95], v18 offset:5712
  s_waitcnt lgkmcnt(4)
  v_mfma_f32_32x32x16_f16 v[64:79], v[80:83], v[84:87], v[64:79]
  ds_read_b64 v[80:81], v18 offset:192
  ds_read_b64 v[84:85], v18 offset:5736
  ds_read_b64 v[82:83], v18 offset:200
  ds_read_b64 v[86:87], v18 offset:5744
  s_waitcnt lgkmcnt(4)
  v_mfma_f32_32x32x16_f16 v[64:79], v[88:91], v[92:95], v[64:79]
  ds_read_b64 v[88:89], v18 offset:224
  ds_read_b64 v[92:93], v18 offset:5768
  ds_read_b64 v[90:91], v18 offset:232
  ds_read_b64 v[94:95], v18 offset:5776
  s_waitcnt lgkmcnt(4)
  v_mfma_f32_32x32x16_f16 v[64:79], v[80:83], v[84:87], v[64:79]
  s_waitcnt lgkmcnt(0)
  v_mfma_f32_32x32x16_f16 v[64:79], v[88:91], v[92:95], v[64:79]
  v_lshlrev_b32 v2, 4, v0
  v_add_u32 v3, s55, v2
  v_add_u32 v4, s60, v2
  v_mov_b32 v5, s55
  v_mov_b32 v6, s60
  v_mov_b32 v7, 1
  s_nop 5
  ds_write_b128 v3, v[64:67] offset:8448
  ds_write_b128 v3, v[68:71] offset:9472
  s_mov_b32 exec_hi, 1
  ds_write_b128 v3, v[72:75] offset:10496
  s_mov_b64 exec, -1
  s_waitcnt lgkmcnt(0)
  ds_write_b32 v5, v7 offset:14076
  s_mov_b32 s58, 0
kg_poll:
  ds_read_b32 v7, v6 offset:14076
  s_add_u32 s58, s58, 1
  s_waitcnt lgkmcnt(0)
  v_readfirstlane_b32 s56, v7
  s_cmp_ge_u32 s56, 1
  s_cbranch_scc1 kg_go
  s_sleep 1
  s_cmp_lt_u32 s58, 0x400000
  s_cbranch_scc1 kg_poll
kg_go:
  ds_read_b128 v[32:35], v4 offset:8448
  ds_read_b128 v[36:39], v4 offset:9472
  ds_read_b128 v[40:43], v4 offset:10496
  s_waitcnt lgkmcnt(0)
  v_add_f32 v64, v64, v32
  v_add_f32 v65, v65, v33
  v_add_f32 v66, v66, v34
  v_add_f32 v67, v67, v35
  v_add_f32 v68, v68, v36
  v_add_f32 v69, v69, v37
  v_add_f32 v70, v70, v38
  v_add_f32 v71, v71, v39
  v_add_f32 v72, v72, v40
  v_add_f32 v73, v73, v41
  v_add_f32 v74, v74, v42
  v_add_f32 v75, v75, v43
  v_mov_b32_dpp v80, v68 wave_shl:1 row_mask:0xf bank_mask:0xf
  v_mov_b32_dpp v81, v69 wave_shl:1 row_mask:0xf bank_mask:0xf
  v_mov_b32_dpp v82, v70 wave_shl:1 row_mask:0xf bank_mask:0xf
  v_mov_b32_dpp v83, v71 wave_shl:1 row_mask:0xf bank_mask:0xf
  v_mov_b32_dpp v84, v72 wave_shl:1 row_mask:0xf bank_mask:0xf
  v_mov_b32_dpp v85, v73 wave_shl:1 row_mask:0xf bank_mask:0xf
  v_mov_b32_dpp v86, v74 wave_shl:1 row_mask:0xf bank_mask:0xf
  v_mov_b32_dpp v87, v75 wave_shl:1 row_mask:0xf bank_mask:0xf
  v_readlane_b32 s84, v70, 32
  v_readlane_b32 s85, v72, 0
  v_readlane_b32 s86, v73, 0
  v_readlane_b32 s87, v74, 0
  v_readlane_b32 s88, v75, 0
  v_readlane_b32 s89, v72, 32
  v_writelane_b32 v80, s84, 63
  v_writelane_b32 v82, s85, 63
  v_writelane_b32 v84, s86, 31
  v_writelane_b32 v85, s87, 31
  v_writelane_b32 v86, s88, 31
  v_writelane_b32 v87, s89, 31
  v_and_b32 v2, 31, v0
  v_lshlrev_b32 v10, 4, v2
  v_add_u32 v10, s55, v10
  v_lshrrev_b32 v3, 5, v0
  v_lshl_add_u32 v11, v3, 3, v10
  v_cvt_pk_f16_f32 v88, v64, v65
  v_cvt_pk_f16_f32 v89, v66, v67
  ds_write_b64 v11, v[88:89] offset:32
  v_and_b32 v2, 1, v0
  v_cmp_eq_u32 vcc, 1, v2
  s_mov_b32 exec_lo, -1
  s_mov_b32 exec_hi, 0
  v_cvt_pk_f16_f32 v92, v68, v68
  v_cvt_pk_f16_f32 v93, v69, v70
  v_cvt_pk_f16_f32 v94, v70, v70
  v_cvt_pk_f16_f32 v95, v71, v80
  ds_write_b128 v10, v[92:95] offset:544
  v_cndmask_b32 v3, v72, v84, vcc
  v_cvt_pk_f16_f32 v88, v72, v72
  v_mov_b32 v89, v88
  v_cvt_pk_f16_f32 v90, v3, v84
  v_cvt_pk_f16_f32 v91, v84, v84
  ds_write_b128 v10, v[88:91] offset:2080
  v_cndmask_b32 v3, v73, v85, vcc
  v_cvt_pk_f16_f32 v92, v73, v73
  v_mov_b32 v93, v92
  v_cvt_pk_f16_f32 v94, v3, v85
  v_cvt_pk_f16_f32 v95, v85, v85
  ds_write_b128 v10, v[92:95] offset:2592
  v_cndmask_b32 v3, v74, v86, vcc
  v_cvt_pk_f16_f32 v88, v74, v74
  v_mov_b32 v89, v88
  v_cvt_pk_f16_f32 v90, v3, v86
  v_cvt_pk_f16_f32 v91, v86, v86
  ds_write_b128 v10, v[88:91] offset:3104
  v_cndmask_b32 v3, v75, v87, vcc
  v_cvt_pk_f16_f32 v92, v75, v75
  v_mov_b32 v93, v92
  v_cvt_pk_f16_f32 v94, v3, v87
  v_cvt_pk_f16_f32 v95, v87, v87
  ds_write_b128 v10, v[92:95] offset:3616
  s_mov_b32 exec_lo, 0
  s_mov_b32 exec_hi, -1
  v_cvt_pk_f16_f32 v88, v68, v68
  v_cvt_pk_f16_f32 v89, v68, v69
  v_cvt_pk_f16_f32 v90, v69, v69
  v_cvt_pk_f16_f32 v91, v80, v80
  ds_write_b128 v10, v[88:91] offset:1056
  v_cvt_pk_f16_f32 v92, v70, v70
  v_cvt_pk_f16_f32 v93, v70, v71
  v_cvt_pk_f16_f32 v94, v71, v71
  v_cvt_pk_f16_f32 v95, v82, v82
  ds_write_b128 v10, v[92:95] offset:1568
  s_mov_b64 exec, 0xff
  v_mov_b32 v4, 0
  ds_write_b32 v17, v4
  s_mov_b64 exec, -1
  v_lshlrev_b32 v2, 4, v0
  v_add_u32 v3, s55, v2
  s_waitcnt lgkmcnt(0)
  ds_read_b128 v[32:35], v3 offset:0
  ds_read_b32 v36, v3 offset:16
  ds_read_b128 v[40:43], v3 offset:1024
  ds_read_b32 v44, v3 offset:1040
  ds_read_b128 v[48:51], v3 offset:2048
  ds_read_b32 v52, v3 offset:2064
  ds_read_b128 v[56:59], v3 offset:3072
  ds_read_b32 v60, v3 offset:3088
  ds_read_b128 v[64:67], v3 offset:4096
  ds_read_b32 v68, v3 offset:4112
  s_waitcnt lgkmcnt(8)
  v_alignbit_b32 v72, v33, v32, 16
  v_alignbit_b32 v73, v34, v33, 16
  v_alignbit_b32 v74, v35, v34, 16
  v_alignbit_b32 v75, v36, v35, 16
  s_waitcnt lgkmcnt(6)
  v_alignbit_b32 v76, v41, v40, 16
  v_alignbit_b32 v77, v42, v41, 16
  v_alignbit_b32 v78, v43, v42, 16
  v_alignbit_b32 v79, v44, v43, 16
  s_waitcnt lgkmcnt(4)
  v_alignbit_b32 v80, v49, v48, 16
  v_alignbit_b32 v81, v50, v49, 16
  v_alignbit_b32 v82, v51, v50, 16
  v_alignbit_b32 v83, v52, v51, 16
  s_waitcnt lgkmcnt(2)
  v_alignbit_b32 v84, v57, v56, 16
  v_alignbit_b32 v85, v58, v57, 16
  v_alignbit_b32 v86, v59, v58, 16
  v_alignbit_b32 v87, v60, v59, 16
  s_waitcnt lgkmcnt(0)
  v_alignbit_b32 v88, v65, v64, 16
  v_alignbit_b32 v89, v66, v65, 16
  v_alignbit_b32 v90, v67, v66, 16
  v_alignbit_b32 v91, v68, v67, 16
  ds_write_b128 v3, v[72:75] offset:4288
  ds_write_b128 v3, v[76:79] offset:5312
  ds_write_b128 v3, v[80:83] offset:6336
  ds_write_b128 v3, v[84:87] offset:7360
  s_mov_b64 exec, 3
  ds_write_b128 v3, v[88:91] offset:8384
  s_mov_b64 exec, -1
  v_mov_b32 v2, 126456
  s_mov_b32 s95, 0
p2_xw:
  ds_read_b32 v3, v2
  s_add_u32 s95, s95, 1
  s_waitcnt lgkmcnt(0)
  v_readfirstlane_b32 s94, v3
  s_cmp_eq_u32 s94, 1
  s_cbranch_scc1 p2_xw_ok
  s_sleep 2
  s_cmp_lt_u32 s95, 0x1000000
  s_cbranch_scc1 p2_xw
p2_xw_ok:
  v_mov_b32 v11, s57
  v_mov_b32 v10, v111
  s_lshl_b32 s57, s54, 12
  v_lshlrev_b32 v10, 16, v10
  v_and_b32 v2, 15, v0
  v_lshrrev_b32 v3, 5, v0
  v_bfe_u32 v4, v0, 4, 1
  v_lshl_add_u32 v5, v3, 4, v2
  v_add_u32 v5, 9, v5
  v_lshlrev_b32 v6, 3, v4
  v_sub_u32 v5, v5, v6
  v_and_b32 v6, 1, v5
  v_sub_u32 v5, v5, v6
  v_lshlrev_b32 v5, 1, v5
  s_movk_i32 s58, 4288
  v_mad_u32_u24 v5, v6, s58, v5
  s_lshl_b32 s56, s61, 8
  s_add_u32 s58, s55, s56
  v_add_u32 v12, s58, v5
  v_add_u32 v13, 1024, v12
  v_add_u32 v14, 2048, v12
  v_add_u32 v15, 3072, v12
  v_sub_u32 v5, v2, v3
  v_lshlrev_b32 v5, 5, v5
  v_lshl_add_u32 v5, v4, 4, v5
  s_mov_b32 s58, s63
  s_sub_u32 s56, s58, s56
  v_add_u32 v16, s56, v5
  v_lshl_add_u32 v5, v2, 1, v3
  v_lshlrev_b32 v5, 4, v5
  v_xor_b32 v6, 1, v4
  v_lshl_add_u32 v5, v6, 3, v5
  s_lshl_b32 s56, s61, 11
  s_add_u32 s58, s58, s56
  v_add_u32 v17, s58, v5
  v_lshrrev_b32 v5, 4, v0
  v_lshlrev_b32 v5, 3, v5
  v_lshl_add_u32 v18, v2, 5, v5
  v_add_u32 v18, s56, v18
  v_mov_b32 v84, 0
  v_mov_b32 v85, 0
  v_mov_b32 v86, 0
  v_mov_b32 v87, 0
  v_mov_b32 v88, 0
  v_mov_b32 v89, 0
  v_mov_b32 v90, 0
  v_mov_b32 v91, 0
  v_mov_b32 v92, 0
  v_mov_b32 v93, 0
  v_mov_b32 v94, 0
  v_mov_b32 v95, 0
  v_mov_b32 v96, 0
  v_mov_b32 v97, 0
  v_mov_b32 v98, 0
  v_mov_b32 v99, 0
  v_mov_b32 v100, 0
  v_mov_b32 v101, 0
  v_mov_b32 v102, 0
  v_mov_b32 v103, 0
  v_mov_b32 v104, 0
  v_mov_b32 v105, 0
  v_mov_b32 v106, 0
  v_mov_b32 v107, 0
  v_mov_b32 v108, 0
  v_mov_b32 v109, 0
  v_mov_b32 v110, 0
  v_mov_b32 v111, 0
  v_mov_b32 v112, 0
  v_mov_b32 v113, 0
  v_mov_b32 v114, 0
  v_mov_b32 v115, 0
  s_waitcnt vmcnt(0) lgkmcnt(0)
  ds_read2_b32 v[20:21], v12 offset0:0 offset1:1
  ds_read2_b32 v[22:23], v12 offset0:2 offset1:3
  ds_read_b128 v[52:55], v16 offset:512
  ds_read2_b32 v[24:25], v12 offset0:128 offset1:129
  ds_read2_b32 v[26:27], v12 offset0:130 offset1:131
  ds_read_b128 v[56:59], v16 offset:1024
  ds_read2_b32 v[28:29], v13 offset0:0 offset1:1
  ds_read2_b32 v[30:31], v13 offset0:2 offset1:3
  ds_read_b128 v[60:63], v16 offset:1536
  ds_read2_b32 v[32:33], v13 offset0:128 offset1:129
  ds_read2_b32 v[34:35], v13 offset0:130 offset1:131
  ds_read_b128 v[64:67], v16 offset:2048
  ds_read2_b32 v[36:37], v14 offset0:0 offset1:1
  ds_read2_b32 v[38:39], v14 offset0:2 offset1:3
  ds_read_b128 v[68:71], v16 offset:2560
  ds_read2_b32 v[40:41], v14 offset0:128 offset1:129
  ds_read2_b32 v[42:43], v14 offset0:130 offset1:131
  ds_read_b128 v[72:75], v16 offset:3072
  ds_read2_b32 v[44:45], v15 offset0:0 offset1:1
  ds_read2_b32 v[46:47], v15 offset0:2 offset1:3
  ds_read_b128 v[76:79], v16 offset:3584
  ds_read2_b32 v[48:49], v15 offset0:128 offset1:129
  ds_read2_b32 v[50:51], v15 offset0:130 offset1:131
  ds_read_b128 v[80:83], v16 offset:4096
  s_mov_b32 s59, 0
k2_cloop:
  s_waitcnt lgkmcnt(0)
  v_mfma_f32_16x16x32_f16 v[84:87], v[20:23], v[52:55], v[84:87]
  ds_read2_b32 a[0:1], v12 offset0:16 offset1:17
  v_mfma_f32_16x16x32_f16 v[88:91], v[20:23], v[56:59], v[88:91]
  ds_read2_b32 a[2:3], v12 offset0:18 offset1:19
  v_mfma_f32_16x16x32_f16 v[92:95], v[20:23], v[60:63], v[92:95]
  ds_read_b128 a[32:35], v16 offset:448
  v_mfma_f32_16x16x32_f16 v[96:99], v[20:23], v[64:67], v[96:99]
  ds_read2_b32 a[4:5], v12 offset0:144 offset1:145
  v_mfma_f32_16x16x32_f16 v[100:103], v[20:23], v[68:71], v[100:103]
  ds_read2_b32 a[6:7], v12 offset0:146 offset1:147
  v_mfma_f32_16x16x32_f16 v[104:107], v[20:23], v[72:75], v[104:107]
  ds_read_b128 a[36:39], v16 offset:960
  v_mfma_f32_16x16x32_f16 v[108:111], v[20:23], v[76:79], v[108:111]
  ds_read2_b32 a[8:9], v13 offset0:16 offset1:17
  v_mfma_f32_16x16x32_f16 v[112:115], v[20:23], v[80:83], v[112:115]
  ds_read2_b32 a[10:11], v13 offset0:18 offset1:19
  v_mfma_f32_16x16x32_f16 v[88:91], v[24:27], v[52:55], v[88:91]
  ds_read_b128 a[40:43], v16 offset:1472
  v_mfma_f32_16x16x32_f16 v[92:95], v[24:27], v[56:59], v[92:95]
  ds_read2_b32 a[12:13], v13 offset0:144 offset1:145
  v_mfma_f32_16x16x32_f16 v[96:99], v[24:27], v[60:63], v[96:99]
  ds_read2_b32 a[14:15], v13 offset0:146 offset1:147
  v_mfma_f32_16x16x32_f16 v[100:103], v[24:27], v[64:67], v[100:103]
  ds_read_b128 a[44:47], v16 offset:1984
  v_mfma_f32_16x16x32_f16 v[104:107], v[24:27], v[68:71], v[104:107]
  ds_read2_b32 a[16:17], v14 offset0:16 offset1:17
  v_mfma_f32_16x16x32_f16 v[108:111], v[24:27], v[72:75], v[108:111]
  ds_read2_b32 a[18:19], v14 offset0:18 offset1:19
  v_mfma_f32_16x16x32_f16 v[112:115], v[24:27], v[76:79], v[112:115]
  ds_read_b128 a[48:51], v16 offset:2496
  v_mfma_f32_16x16x32_f16 v[92:95], v[28:31], v[52:55], v[92:95]
  ds_read2_b32 a[20:21], v14 offset0:144 offset1:145
  v_mfma_f32_16x16x32_f16 v[96:99], v[28:31], v[56:59], v[96:99]
  ds_read2_b32 a[22:23], v14 offset0:146 offset1:147
  v_mfma_f32_16x16x32_f16 v[100:103], v[28:31], v[60:63], v[100:103]
  ds_read_b128 a[52:55], v16 offset:3008
  v_mfma_f32_16x16x32_f16 v[104:107], v[28:31], v[64:67], v[104:107]
  ds_read2_b32 a[24:25], v15 offset0:16 offset1:17
  v_mfma_f32_16x16x32_f16 v[108:111], v[28:31], v[68:71], v[108:111]
  ds_read2_b32 a[26:27], v15 offset0:18 offset1:19
  v_mfma_f32_16x16x32_f16 v[112:115], v[28:31], v[72:75], v[112:115]
  ds_read_b128 a[56:59], v16 offset:3520
  v_mfma_f32_16x16x32_f16 v[96:99], v[32:35], v[52:55], v[96:99]
  ds_read2_b32 a[28:29], v15 offset0:144 offset1:145
  v_mfma_f32_16x16x32_f16 v[100:103], v[32:35], v[56:59], v[100:103]
  ds_read2_b32 a[30:31], v15 offset0:146 offset1:147
  v_mfma_f32_16x16x32_f16 v[104:107], v[32:35], v[60:63], v[104:107]
  ds_read_b128 a[60:63], v16 offset:4032
  v_mfma_f32_16x16x32_f16 v[108:111], v[32:35], v[64:67], v[108:111]
  v_mfma_f32_16x16x32_f16 v[112:115], v[32:35], v[68:71], v[112:115]
  v_mfma_f32_16x16x32_f16 v[100:103], v[36:39], v[52:55], v[100:103]
  v_mfma_f32_16x16x32_f16 v[104:107], v[36:39], v[56:59], v[104:107]
  v_mfma_f32_16x16x32_f16 v[108:111], v[36:39], v[60:63], v[108:111]
  v_mfma_f32_16x16x32_f16 v[112:115], v[36:39], v[64:67], v[112:115]
  v_mfma_f32_16x16x32_f16 v[104:107], v[40:43], v[52:55], v[104:107]
  v_mfma_f32_16x16x32_f16 v[108:111], v[40:43], v[56:59], v[108:111]
  v_mfma_f32_16x16x32_f16 v[112:115], v[40:43], v[60:63], v[112:115]
  v_mfma_f32_16x16x32_f16 v[108:111], v[44:47], v[52:55], v[108:111]
  v_mfma_f32_16x16x32_f16 v[112:115], v[44:47], v[56:59], v[112:115]
  v_mfma_f32_16x16x32_f16 v[112:115], v[48:51], v[52:55], v[112:115]
  s_waitcnt lgkmcnt(0)
  v_mfma_f32_16x16x32_f16 v[84:87], a[0:3], a[32:35], v[84:87]
  ds_read2_b32 v[20:21], v12 offset0:32 offset1:33
  v_mfma_f32_16x16x32_f16 v[88:91], a[0:3], a[36:39], v[88:91]
  ds_read2_b32 v[22:23], v12 offset0:34 offset1:35
  v_mfma_f32_16x16x32_f16 v[92:95], a[0:3], a[40:43], v[92:95]
  ds_read_b128 v[52:55], v16 offset:384
  v_mfma_f32_16x16x32_f16 v[96:99], a[0:3], a[44:47], v[96:99]
  ds_read2_b32 v[24:25], v12 offset0:160 offset1:161
  v_mfma_f32_16x16x32_f16 v[100:103], a[0:3], a[48:51], v[100:103]
  ds_read2_b32 v[26:27], v12 offset0:162 offset1:163
  v_mfma_f32_16x16x32_f16 v[104:107], a[0:3], a[52:55], v[104:107]
  ds_read_b128 v[56:59], v16 offset:896
  v_mfma_f32_16x16x32_f16 v[108:111], a[0:3], a[56:59], v[108:111]
  ds_read2_b32 v[28:29], v13 offset0:32 offset1:33
  v_mfma_f32_16x16x32_f16 v[112:115], a[0:3], a[60:63], v[112:115]
  ds_read2_b32 v[30:31], v13 offset0:34 offset1:35
  v_mfma_f32_16x16x32_f16 v[88:91], a[4:7], a[32:35], v[88:91]
  ds_read_b128 v[60:63], v16 offset:1408
  v_mfma_f32_16x16x32_f16 v[92:95], a[4:7], a[36:39], v[92:95]
  ds_read2_b32 v[32:33], v13 offset0:160 offset1:161
  v_mfma_f32_16x16x32_f16 v[96:99], a[4:7], a[40:43], v[96:99]
  ds_read2_b32 v[34:35], v13 offset0:162 offset1:163
  v_mfma_f32_16x16x32_f16 v[100:103], a[4:7], a[44:47], v[100:103]
  ds_read_b128 v[64:67], v16 offset:1920
  v_mfma_f32_16x16x32_f16 v[104:107], a[4:7], a[48:51], v[104:107]
  ds_read2_b32 v[36:37], v14 offset0:32 offset1:33
  v_mfma_f32_16x16x32_f16 v[108:111], a[4:7], a[52:55], v[108:111]
  ds_read2_b32 v[38:39], v14 offset0:34 offset1:35
  v_mfma_f32_16x16x32_f16 v[112:115], a[4:7], a[56:59], v[112:115]
  ds_read_b128 v[68:71], v16 offset:2432
  v_mfma_f32_16x16x32_f16 v[92:95], a[8:11], a[32:35], v[92:95]
  ds_read2_b32 v[40:41], v14 offset0:160 offset1:161
  v_mfma_f32_16x16x32_f16 v[96:99], a[8:11], a[36:39], v[96:99]
  ds_read2_b32 v[42:43], v14 offset0:162 offset1:163
  v_mfma_f32_16x16x32_f16 v[100:103], a[8:11], a[40:43], v[100:103]
  ds_read_b128 v[72:75], v16 offset:2944
  v_mfma_f32_16x16x32_f16 v[104:107], a[8:11], a[44:47], v[104:107]
  ds_read2_b32 v[44:45], v15 offset0:32 offset1:33
  v_mfma_f32_16x16x32_f16 v[108:111], a[8:11], a[48:51], v[108:111]
  ds_read2_b32 v[46:47], v15 offset0:34 offset1:35
  v_mfma_f32_16x16x32_f16 v[112:115], a[8:11], a[52:55], v[112:115]
  ds_read_b128 v[76:79], v16 offset:3456
  v_mfma_f32_16x16x32_f16 v[96:99], a[12:15], a[32:35], v[96:99]
  ds_read2_b32 v[48:49], v15 offset0:160 offset1:161
  v_mfma_f32_16x16x32_f16 v[100:103], a[12:15], a[36:39], v[100:103]
  ds_read2_b32 v[50:51], v15 offset0:162 offset1:163
  v_mfma_f32_16x16x32_f16 v[104:107], a[12:15], a[40:43], v[104:107]
  ds_read_b128 v[80:83], v16 offset:3968
  v_mfma_f32_16x16x32_f16 v[108:111], a[12:15], a[44:47], v[108:111]
  v_mfma_f32_16x16x32_f16 v[112:115], a[12:15], a[48:51], v[112:115]
  v_mfma_f32_16x16x32_f16 v[100:103], a[16:19], a[32:35], v[100:103]
  v_mfma_f32_16x16x32_f16 v[104:107], a[16:19], a[36:39], v[104:107]
  v_mfma_f32_16x16x32_f16 v[108:111], a[16:19], a[40:43], v[108:111]
  v_mfma_f32_16x16x32_f16 v[112:115], a[16:19], a[44:47], v[112:115]
  v_mfma_f32_16x16x32_f16 v[104:107], a[20:23], a[32:35], v[104:107]
  v_mfma_f32_16x16x32_f16 v[108:111], a[20:23], a[36:39], v[108:111]
  v_mfma_f32_16x16x32_f16 v[112:115], a[20:23], a[40:43], v[112:115]
  v_mfma_f32_16x16x32_f16 v[108:111], a[24:27], a[32:35], v[108:111]
  v_mfma_f32_16x16x32_f16 v[112:115], a[24:27], a[36:39], v[112:115]
  v_mfma_f32_16x16x32_f16 v[112:115], a[28:31], a[32:35], v[112:115]
  v_add_u32 v12, 128, v12
  v_add_u32 v13, 128, v13
  v_add_u32 v14, 128, v14
  v_add_u32 v15, 128, v15
  v_subrev_u32 v16, 128, v16
  s_add_u32 s59, s59, 1
  s_cmp_lt_u32 s59, 2
  s_cbranch_scc1 k2_cloop
  s_waitcnt lgkmcnt(0)
  v_lshlrev_b32 v2, 4, v0
  v_add_u32 v3, s55, v2
  ds_write_b128 v3, v[84:87] offset:0
  ds_write_b128 v3, v[88:91] offset:1024
  ds_write_b128 v3, v[92:95] offset:2048
  ds_write_b128 v3, v[96:99] offset:3072
  ds_write_b128 v3, v[100:103] offset:4096
  ds_write_b128 v3, v[104:107] offset:5120
  ds_write_b128 v3, v[108:111] offset:6144
  ds_write_b128 v3, v[112:115] offset:7168
  v_mov_b32 v5, s55
  v_mov_b32 v6, s60
  v_mov_b32 v7, 2
  s_lshl_b32 s56, s61, 12
  s_add_u32 s58, s56, s60
  s_add_u32 s56, s56, s55
  v_add_u32 v3, s56, v2
  v_add_u32 v4, s58, v2
  s_waitcnt lgkmcnt(0)
  ds_write_b32 v5, v7 offset:14076
  ds_read_b128 v[84:87], v3 offset:0
  ds_read_b64 v[20:21], v17 offset:512
  ds_read_b128 v[88:91], v3 offset:1024
  ds_read_b64 v[22:23], v17 offset:1024
  ds_read_b128 v[92:95], v3 offset:2048
  ds_read_b64 v[24:25], v17 offset:1536
  ds_read_b128 v[96:99], v3 offset:3072
  ds_read_b64 v[26:27], v17 offset:2048
  s_mov_b32 s58, 0
k2_cp:
  ds_read_b32 v7, v6 offset:14076
  s_add_u32 s58, s58, 1
  s_waitcnt lgkmcnt(0)
  v_readfirstlane_b32 s56, v7
  s_cmp_eq_u32 s56, 2
  s_cbranch_scc1 k2_cg
  s_sleep 1
  s_cmp_lt_u32 s58, 0x400000
  s_cbranch_scc1 k2_cp
k2_cg:
  ds_read_b128 v[100:103], v4 offset:0
  ds_read_b128 v[104:107], v4 offset:1024
  ds_read_b128 v[108:111], v4 offset:2048
  ds_read_b128 v[112:115], v4 offset:3072
  s_mov_b32 s62, 0xffff0000
  s_waitcnt lgkmcnt(0)
  v_add_f32 v84, v84, v100
  v_add_f32 v85, v85, v101
  v_add_f32 v86, v86, v102
  v_add_f32 v87, v87, v103
  v_mul_f32 v84, v84, v11
  v_mul_f32 v85, v85, v11
  v_mul_f32 v86, v86, v11
  v_mul_f32 v87, v87, v11
  v_cvt_pk_bf16_f32 v2, v84, v85
  v_cvt_pk_bf16_f32 v3, v86, v87
  v_cvt_f32_f16_sdwa v84, v21 dst_sel:DWORD dst_unused:UNUSED_PAD src0_sel:WORD_1
  v_cvt_f32_f16 v85, v21
  v_cvt_f32_f16_sdwa v86, v20 dst_sel:DWORD dst_unused:UNUSED_PAD src0_sel:WORD_1
  v_cvt_f32_f16 v87, v20
  v_mul_f32 v84, v84, v10
  v_mul_f32 v85, v85, v10
  v_mul_f32 v86, v86, v10
  v_mul_f32 v87, v87, v10
  v_cvt_pk_bf16_f32 v4, v84, v85
  v_cvt_pk_bf16_f32 v5, v86, v87
  v_lshlrev_b32 v84, 16, v2
  v_and_b32 v85, s62, v2
  v_lshlrev_b32 v6, 16, v4
  v_and_b32 v7, s62, v4
  v_add_f32 v84, v84, v6
  v_add_f32 v85, v85, v7
  v_lshlrev_b32 v86, 16, v3
  v_and_b32 v87, s62, v3
  v_lshlrev_b32 v6, 16, v5
  v_and_b32 v7, s62, v5
  v_add_f32 v86, v86, v6
  v_add_f32 v87, v87, v7
  v_cvt_pk_bf16_f32 v52, v84, v85
  v_cvt_pk_bf16_f32 v53, v86, v87
  buffer_store_dwordx2 v[52:53], v18, s[40:43], s57 offen offset:0 sc1
  v_add_f32 v88, v88, v104
  v_add_f32 v89, v89, v105
  v_add_f32 v90, v90, v106
  v_add_f32 v91, v91, v107
  v_mul_f32 v88, v88, v11
  v_mul_f32 v89, v89, v11
  v_mul_f32 v90, v90, v11
  v_mul_f32 v91, v91, v11
  v_cvt_pk_bf16_f32 v2, v88, v89
  v_cvt_pk_bf16_f32 v3, v90, v91
  v_cvt_f32_f16_sdwa v88, v23 dst_sel:DWORD dst_unused:UNUSED_PAD src0_sel:WORD_1
  v_cvt_f32_f16 v89, v23
  v_cvt_f32_f16_sdwa v90, v22 dst_sel:DWORD dst_unused:UNUSED_PAD src0_sel:WORD_1
  v_cvt_f32_f16 v91, v22
  v_mul_f32 v88, v88, v10
  v_mul_f32 v89, v89, v10
  v_mul_f32 v90, v90, v10
  v_mul_f32 v91, v91, v10
  v_cvt_pk_bf16_f32 v4, v88, v89
  v_cvt_pk_bf16_f32 v5, v90, v91
  v_lshlrev_b32 v88, 16, v2
  v_and_b32 v89, s62, v2
  v_lshlrev_b32 v6, 16, v4
  v_and_b32 v7, s62, v4
  v_add_f32 v88, v88, v6
  v_add_f32 v89, v89, v7
  v_lshlrev_b32 v90, 16, v3
  v_and_b32 v91, s62, v3
  v_lshlrev_b32 v6, 16, v5
  v_and_b32 v7, s62, v5
  v_add_f32 v90, v90, v6
  v_add_f32 v91, v91, v7
  v_cvt_pk_bf16_f32 v54, v88, v89
  v_cvt_pk_bf16_f32 v55, v90, v91
  buffer_store_dwordx2 v[54:55], v18, s[40:43], s57 offen offset:512 sc1
  v_add_f32 v92, v92, v108
  v_add_f32 v93, v93, v109
  v_add_f32 v94, v94, v110
  v_add_f32 v95, v95, v111
  v_mul_f32 v92, v92, v11
  v_mul_f32 v93, v93, v11
  v_mul_f32 v94, v94, v11
  v_mul_f32 v95, v95, v11
  v_cvt_pk_bf16_f32 v2, v92, v93
  v_cvt_pk_bf16_f32 v3, v94, v95
  v_cvt_f32_f16_sdwa v92, v25 dst_sel:DWORD dst_unused:UNUSED_PAD src0_sel:WORD_1
  v_cvt_f32_f16 v93, v25
  v_cvt_f32_f16_sdwa v94, v24 dst_sel:DWORD dst_unused:UNUSED_PAD src0_sel:WORD_1
  v_cvt_f32_f16 v95, v24
  v_mul_f32 v92, v92, v10
  v_mul_f32 v93, v93, v10
  v_mul_f32 v94, v94, v10
  v_mul_f32 v95, v95, v10
  v_cvt_pk_bf16_f32 v4, v92, v93
  v_cvt_pk_bf16_f32 v5, v94, v95
  v_lshlrev_b32 v92, 16, v2
  v_and_b32 v93, s62, v2
  v_lshlrev_b32 v6, 16, v4
  v_and_b32 v7, s62, v4
  v_add_f32 v92, v92, v6
  v_add_f32 v93, v93, v7
  v_lshlrev_b32 v94, 16, v3
  v_and_b32 v95, s62, v3
  v_lshlrev_b32 v6, 16, v5
  v_and_b32 v7, s62, v5
  v_add_f32 v94, v94, v6
  v_add_f32 v95, v95, v7
  v_cvt_pk_bf16_f32 v56, v92, v93
  v_cvt_pk_bf16_f32 v57, v94, v95
  buffer_store_dwordx2 v[56:57], v18, s[40:43], s57 offen offset:1024 sc1
  v_add_f32 v96, v96, v112
  v_add_f32 v97, v97, v113
  v_add_f32 v98, v98, v114
  v_add_f32 v99, v99, v115
  v_mul_f32 v96, v96, v11
  v_mul_f32 v97, v97, v11
  v_mul_f32 v98, v98, v11
  v_mul_f32 v99, v99, v11
  v_cvt_pk_bf16_f32 v2, v96, v97
  v_cvt_pk_bf16_f32 v3, v98, v99
  v_cvt_f32_f16_sdwa v96, v27 dst_sel:DWORD dst_unused:UNUSED_PAD src0_sel:WORD_1
  v_cvt_f32_f16 v97, v27
  v_cvt_f32_f16_sdwa v98, v26 dst_sel:DWORD dst_unused:UNUSED_PAD src0_sel:WORD_1
  v_cvt_f32_f16 v99, v26
  v_mul_f32 v96, v96, v10
  v_mul_f32 v97, v97, v10
  v_mul_f32 v98, v98, v10
  v_mul_f32 v99, v99, v10
  v_cvt_pk_bf16_f32 v4, v96, v97
  v_cvt_pk_bf16_f32 v5, v98, v99
  v_lshlrev_b32 v96, 16, v2
  v_and_b32 v97, s62, v2
  v_lshlrev_b32 v6, 16, v4
  v_and_b32 v7, s62, v4
  v_add_f32 v96, v96, v6
  v_add_f32 v97, v97, v7
  v_lshlrev_b32 v98, 16, v3
  v_and_b32 v99, s62, v3
  v_lshlrev_b32 v6, 16, v5
  v_and_b32 v7, s62, v5
  v_add_f32 v98, v98, v6
  v_add_f32 v99, v99, v7
  v_cvt_pk_bf16_f32 v58, v96, v97
  v_cvt_pk_bf16_f32 v59, v98, v99
  buffer_store_dwordx2 v[58:59], v18, s[40:43], s57 offen offset:1536 sc1
k2_ctail:
  s_lshl_b32 s53, s2, 2
  s_add_u32 s53, s53, s52
  s_lshl_b32 s53, s53, 3
  s_add_u32 s53, s53, 28344320
  v_mov_b32 v2, s53
  v_mov_b32 v4, s96
  v_mov_b32 v5, s97
  s_waitcnt vmcnt(0)
  s_mov_b64 exec, 1
  global_store_dwordx2 v2, v[4:5], s[8:9] sc0 sc1
  s_mov_b64 exec, -1
  s_branch p2_done
p2_done:
  s_setprio 0
  s_and_b32 s12, s2, 7
  s_lshr_b32 s13, s2, 3
  s_lshl_b32 s14, s12, 2
  s_and_b32 s15, s13, 3
  s_add_u32 s14, s14, s15
  s_lshr_b32 s15, s13, 2
  s_add_u32 s24, s8, 8388608
  s_addc_u32 s25, s9, 0
  s_and_b32 s25, s25, 0xffff
  s_mov_b32 s26, 4194304
  s_mov_b32 s27, 0x00020000
  s_add_u32 s28, s8, 25165824
  s_addc_u32 s29, s9, 0
  s_and_b32 s29, s29, 0xffff
  s_mov_b32 s30, 917504
  s_mov_b32 s31, 0x00020000
  s_add_u32 s32, s8, 14680064
  s_addc_u32 s33, s9, 0
  s_and_b32 s33, s33, 0xffff
  s_mov_b32 s34, 2097152
  s_mov_b32 s35, 0x00020000
  v_lshlrev_b32 v10, 4, v0
  s_add_u32 s53, s3, 0
  s_and_b32 s53, s53, 3
  s_lshl_b32 s53, s53, 10
  v_add_u32 v12, s53, v10
  s_add_u32 s53, s3, 1
  s_and_b32 s53, s53, 3
  s_lshl_b32 s53, s53, 10
  v_add_u32 v13, s53, v10
  s_add_u32 s53, s3, 2
  s_and_b32 s53, s53, 3
  s_lshl_b32 s53, s53, 10
  v_add_u32 v14, s53, v10
  s_add_u32 s53, s3, 3
  s_and_b32 s53, s53, 3
  s_lshl_b32 s53, s53, 10
  v_add_u32 v15, s53, v10
  s_lshr_b32 s59, s3, 2
  s_lshl_b32 s53, s59, 11
  v_add_u32 v16, s53, v10
  v_xor_b32 v17, 2048, v16
  s_lshl_b32 s52, s3, 2
  s_mul_i32 s53, s3, 3
  s_add_u32 s53, s53, 4
  s_cmp_lt_u32 s3, 4
  s_cselect_b32 s52, s52, s53
  s_mul_i32 s54, s14, 28
  s_add_u32 s54, s54, s52
  s_lshl_b32 s54, s54, 12
  s_mul_i32 s55, s15, 28
  s_add_u32 s55, s55, s52
  s_lshl_b32 s55, s55, 12
  s_waitcnt lgkmcnt(0)
  s_mov_b32 s16, s4
  s_and_b32 s17, s5, 0xffff
  s_mov_b32 s18, 2097152
  s_mov_b32 s19, 0x00020000
  s_mov_b32 s20, s100
  s_and_b32 s21, s101, 0xffff
  s_mov_b32 s22, 2097152
  s_mov_b32 s23, 0x00020000
  v_and_b32 v2, 15, v0
  v_lshrrev_b32 v3, 4, v0
  v_lshlrev_b32 v2, 10, v2
  v_lshl_add_u32 v11, v3, 4, v2
  s_lshl_b32 s58, s14, 16
  s_and_b32 s57, s3, 3
  s_lshl_b32 s57, s57, 14
  s_add_u32 s58, s58, s57
  s_lshl_b32 s57, s15, 7
  s_add_u32 s58, s58, s57
  s_lshl_b32 s57, s59, 6
  s_add_u32 s58, s58, s57
  buffer_load_dwordx4 v[20:23], v11, s[16:19], s58 offen
  s_lshl_b32 s53, s14, 7
  s_add_u32 s53, s53, 28348416
  s_lshl_b32 s57, s15, 8
  s_add_u32 s57, s57, 28344256
  v_mov_b32 v2, s53
  v_mov_b32 v3, s57
  v_cmp_gt_u32 vcc, 8, v0
  s_nop 1
  v_cndmask_b32 v2, v3, v2, vcc
  v_lshl_add_u32 v2, v0, 3, v2
  s_lshl_b32 s53, s14, 7
  s_add_u32 s53, s53, 28352512
  v_lshlrev_b32 v2, 3, v0
  v_add_u32 v2, s53, v2
  s_add_u32 s44, s8, 25165824
  s_addc_u32 s45, s9, 0
  s_and_b32 s45, s45, 0xffff
  s_mov_b32 s46, 917504
  s_mov_b32 s47, 0x00020000
  s_lshl_b32 s84, s3, 2
  s_mul_i32 s85, s3, 3
  s_add_u32 s85, s85, 4
  s_cmp_lt_u32 s3, 4
  s_cselect_b32 s84, s84, s85
  s_lshr_b32 s85, s2, 5
  s_mul_i32 s85, s85, 28
  s_add_u32 s85, s85, s84
  s_lshl_b32 s85, s85, 12
  s_lshr_b32 s86, s3, 2
  s_lshl_b32 s86, s86, 11
  v_lshlrev_b32 v1, 4, v0
  s_xor_b32 s87, s86, 0
  s_add_u32 s87, s87, s85
  s_add_u32 s87, s87, 0
  buffer_load_dwordx4 a[4:7], v1, s[44:47], s87 offen offset:0 sc1
  buffer_load_dwordx4 a[8:11], v1, s[44:47], s87 offen offset:1024 sc1
  s_xor_b32 s87, s86, 2048
  s_add_u32 s87, s87, s85
  s_add_u32 s87, s87, 0
  buffer_load_dwordx4 a[12:15], v1, s[44:47], s87 offen offset:0 sc1
  buffer_load_dwordx4 a[20:23], v1, s[44:47], s87 offen offset:1024 sc1
  s_xor_b32 s87, s86, 0
  s_add_u32 s87, s87, s85
  s_add_u32 s87, s87, 4096
  buffer_load_dwordx4 a[24:27], v1, s[44:47], s87 offen offset:0 sc1
  buffer_load_dwordx4 a[28:31], v1, s[44:47], s87 offen offset:1024 sc1
  s_xor_b32 s87, s86, 2048
  s_add_u32 s87, s87, s85
  s_add_u32 s87, s87, 4096
  buffer_load_dwordx4 a[36:39], v1, s[44:47], s87 offen offset:0 sc1
  buffer_load_dwordx4 a[40:43], v1, s[44:47], s87 offen offset:1024 sc1
  s_xor_b32 s87, s86, 0
  s_add_u32 s87, s87, s85
  s_add_u32 s87, s87, 8192
  buffer_load_dwordx4 a[44:47], v1, s[44:47], s87 offen offset:0 sc1
  buffer_load_dwordx4 a[52:55], v1, s[44:47], s87 offen offset:1024 sc1
  s_xor_b32 s87, s86, 2048
  s_add_u32 s87, s87, s85
  s_add_u32 s87, s87, 8192
  buffer_load_dwordx4 a[56:59], v1, s[44:47], s87 offen offset:0 sc1
  buffer_load_dwordx4 a[60:63], v1, s[44:47], s87 offen offset:1024 sc1
  s_xor_b32 s87, s86, 0
  s_add_u32 s87, s87, s85
  s_add_u32 s87, s87, 12288
  buffer_load_dwordx4 a[68:71], v1, s[44:47], s87 offen offset:0 sc1
  buffer_load_dwordx4 a[72:75], v1, s[44:47], s87 offen offset:1024 sc1
  s_xor_b32 s87, s86, 2048
  s_add_u32 s87, s87, s85
  s_add_u32 s87, s87, 12288
  buffer_load_dwordx4 a[76:79], v1, s[44:47], s87 offen offset:0 sc1
  buffer_load_dwordx4 a[84:87], v1, s[44:47], s87 offen offset:1024 sc1
  s_cmp_lg_u32 s3, 0
  s_cbranch_scc1 p3_np
  s_mov_b32 exec_lo, 0xff
  s_mov_b32 exec_hi, 0x0
  s_mov_b32 s95, 0
p3_poll:
  global_load_dwordx2 v[4:5], v2, s[8:9] sc0 sc1
  s_add_u32 s95, s95, 1
  s_waitcnt vmcnt(0)
  v_cmp_ne_u64 vcc, s[96:97], v[4:5]
  s_nop 1
  s_cmp_eq_u64 vcc, 0
  s_cbranch_scc1 p3_poll_ok
  s_sleep 2
  s_cmp_lt_u32 s95, 0x100000
  s_cbranch_scc1 p3_poll
p3_poll_ok:
  s_mov_b64 exec, -1
p3_np:
  s_barrier
  v_lshrrev_b32 v2, 3, v0
  v_and_b32 v3, 7, v0
  v_lshlrev_b32 v3, 4, v3
  v_lshl_add_u32 v3, v2, 12, v3
  s_lshl_b32 s56, s15, 18
  s_lshl_b32 s57, s3, 15
  s_add_u32 s56, s56, s57
  s_lshl_b32 s57, s14, 7
  s_add_u32 s60, s56, s57
  s_lshl_b32 s57, s3, 10
  s_add_u32 m0, s57, 114688
  s_cmp_ge_u32 s3, 4
  s_cbranch_scc1 p3_3
  s_add_u32 s56, s54, 0
  buffer_load_dwordx4 v[80:83], v12, s[24:27], s56 offen sc1
  buffer_load_dwordx4 v[84:87], v13, s[24:27], s56 offen sc1
  buffer_load_dwordx4 v[88:91], v14, s[24:27], s56 offen sc1
  buffer_load_dwordx4 v[92:95], v15, s[24:27], s56 offen sc1
  s_add_u32 s56, s54, 4096
  buffer_load_dwordx4 v[96:99], v12, s[24:27], s56 offen sc1
  buffer_load_dwordx4 v[100:103], v13, s[24:27], s56 offen sc1
  buffer_load_dwordx4 v[104:107], v14, s[24:27], s56 offen sc1
  buffer_load_dwordx4 v[108:111], v15, s[24:27], s56 offen sc1
  s_add_u32 s56, s54, 8192
  buffer_load_dwordx4 v[112:115], v12, s[24:27], s56 offen sc1
  buffer_load_dwordx4 v[116:119], v13, s[24:27], s56 offen sc1
  buffer_load_dwordx4 v[120:123], v14, s[24:27], s56 offen sc1
  buffer_load_dwordx4 v[124:127], v15, s[24:27], s56 offen sc1
  s_add_u32 s56, s54, 12288
  buffer_load_dwordx4 v[128:131], v12, s[24:27], s56 offen sc1
  buffer_load_dwordx4 v[132:135], v13, s[24:27], s56 offen sc1
  buffer_load_dwordx4 v[136:139], v14, s[24:27], s56 offen sc1
  buffer_load_dwordx4 v[140:143], v15, s[24:27], s56 offen sc1
  s_waitcnt vmcnt(12)
  v_mfma_f32_16x16x32_bf16 v[24:27], a[4:7], v[80:83], 0
  v_mfma_f32_16x16x32_bf16 a[88:91], a[4:7], v[84:87], 0
  v_mfma_f32_16x16x32_bf16 a[100:103], a[4:7], v[88:91], 0
  v_mfma_f32_16x16x32_bf16 a[108:111], a[4:7], v[92:95], 0
  v_mfma_f32_16x16x32_bf16 v[28:31], a[8:11], v[80:83], 0
  v_mfma_f32_16x16x32_bf16 a[92:95], a[8:11], v[84:87], 0
  v_mfma_f32_16x16x32_bf16 a[104:107], a[8:11], v[88:91], 0
  v_mfma_f32_16x16x32_bf16 a[0:3], a[8:11], v[92:95], 0
  v_mfma_f32_16x16x32_bf16 a[16:19], a[12:15], v[80:83], 0
  v_mfma_f32_16x16x32_bf16 a[48:51], a[12:15], v[84:87], 0
  v_mfma_f32_16x16x32_bf16 a[80:83], a[12:15], v[88:91], 0
  v_mfma_f32_16x16x32_bf16 v[32:35], a[12:15], v[92:95], 0
  v_mfma_f32_16x16x32_bf16 a[32:35], a[20:23], v[80:83], 0
  v_mfma_f32_16x16x32_bf16 a[64:67], a[20:23], v[84:87], 0
  v_mfma_f32_16x16x32_bf16 a[96:99], a[20:23], v[88:91], 0
  v_mfma_f32_16x16x32_bf16 v[36:39], a[20:23], v[92:95], 0
  s_waitcnt vmcnt(8)
  v_mfma_f32_16x16x32_bf16 v[24:27], a[24:27], v[96:99], v[24:27]
  v_mfma_f32_16x16x32_bf16 a[88:91], a[24:27], v[100:103], a[88:91]
  v_mfma_f32_16x16x32_bf16 a[100:103], a[24:27], v[104:107], a[100:103]
  v_mfma_f32_16x16x32_bf16 a[108:111], a[24:27], v[108:111], a[108:111]
  v_mfma_f32_16x16x32_bf16 v[28:31], a[28:31], v[96:99], v[28:31]
  v_mfma_f32_16x16x32_bf16 a[92:95], a[28:31], v[100:103], a[92:95]
  v_mfma_f32_16x16x32_bf16 a[104:107], a[28:31], v[104:107], a[104:107]
  v_mfma_f32_16x16x32_bf16 a[0:3], a[28:31], v[108:111], a[0:3]
  v_mfma_f32_16x16x32_bf16 a[16:19], a[36:39], v[96:99], a[16:19]
  v_mfma_f32_16x16x32_bf16 a[48:51], a[36:39], v[100:103], a[48:51]
  v_mfma_f32_16x16x32_bf16 a[80:83], a[36:39], v[104:107], a[80:83]
  v_mfma_f32_16x16x32_bf16 v[32:35], a[36:39], v[108:111], v[32:35]
  v_mfma_f32_16x16x32_bf16 a[32:35], a[40:43], v[96:99], a[32:35]
  v_mfma_f32_16x16x32_bf16 a[64:67], a[40:43], v[100:103], a[64:67]
  v_mfma_f32_16x16x32_bf16 a[96:99], a[40:43], v[104:107], a[96:99]
  v_mfma_f32_16x16x32_bf16 v[36:39], a[40:43], v[108:111], v[36:39]
  s_waitcnt vmcnt(4)
  v_mfma_f32_16x16x32_bf16 v[24:27], a[44:47], v[112:115], v[24:27]
  v_mfma_f32_16x16x32_bf16 a[88:91], a[44:47], v[116:119], a[88:91]
  v_mfma_f32_16x16x32_bf16 a[100:103], a[44:47], v[120:123], a[100:103]
  v_mfma_f32_16x16x32_bf16 a[108:111], a[44:47], v[124:127], a[108:111]
  v_mfma_f32_16x16x32_bf16 v[28:31], a[52:55], v[112:115], v[28:31]
  v_mfma_f32_16x16x32_bf16 a[92:95], a[52:55], v[116:119], a[92:95]
  v_mfma_f32_16x16x32_bf16 a[104:107], a[52:55], v[120:123], a[104:107]
  v_mfma_f32_16x16x32_bf16 a[0:3], a[52:55], v[124:127], a[0:3]
  v_mfma_f32_16x16x32_bf16 a[16:19], a[56:59], v[112:115], a[16:19]
  v_mfma_f32_16x16x32_bf16 a[48:51], a[56:59], v[116:119], a[48:51]
  v_mfma_f32_16x16x32_bf16 a[80:83], a[56:59], v[120:123], a[80:83]
  v_mfma_f32_16x16x32_bf16 v[32:35], a[56:59], v[124:127], v[32:35]
  v_mfma_f32_16x16x32_bf16 a[32:35], a[60:63], v[112:115], a[32:35]
  v_mfma_f32_16x16x32_bf16 a[64:67], a[60:63], v[116:119], a[64:67]
  v_mfma_f32_16x16x32_bf16 a[96:99], a[60:63], v[120:123], a[96:99]
  v_mfma_f32_16x16x32_bf16 v[36:39], a[60:63], v[124:127], v[36:39]
  s_waitcnt vmcnt(0)
  v_mfma_f32_16x16x32_bf16 v[24:27], a[68:71], v[128:131], v[24:27]
  v_mfma_f32_16x16x32_bf16 a[88:91], a[68:71], v[132:135], a[88:91]
  v_mfma_f32_16x16x32_bf16 a[100:103], a[68:71], v[136:139], a[100:103]
  v_mfma_f32_16x16x32_bf16 a[108:111], a[68:71], v[140:143], a[108:111]
  v_mfma_f32_16x16x32_bf16 v[28:31], a[72:75], v[128:131], v[28:31]
  v_mfma_f32_16x16x32_bf16 a[92:95], a[72:75], v[132:135], a[92:95]
  v_mfma_f32_16x16x32_bf16 a[104:107], a[72:75], v[136:139], a[104:107]
  v_mfma_f32_16x16x32_bf16 a[0:3], a[72:75], v[140:143], a[0:3]
  v_mfma_f32_16x16x32_bf16 a[16:19], a[76:79], v[128:131], a[16:19]
  v_mfma_f32_16x16x32_bf16 a[48:51], a[76:79], v[132:135], a[48:51]
  v_mfma_f32_16x16x32_bf16 a[80:83], a[76:79], v[136:139], a[80:83]
  v_mfma_f32_16x16x32_bf16 v[32:35], a[76:79], v[140:143], v[32:35]
  v_mfma_f32_16x16x32_bf16 a[32:35], a[84:87], v[128:131], a[32:35]
  v_mfma_f32_16x16x32_bf16 a[64:67], a[84:87], v[132:135], a[64:67]
  v_mfma_f32_16x16x32_bf16 a[96:99], a[84:87], v[136:139], a[96:99]
  v_mfma_f32_16x16x32_bf16 v[36:39], a[84:87], v[140:143], v[36:39]
  s_branch p3_red
p3_3:
  s_add_u32 s56, s54, 0
  buffer_load_dwordx4 v[80:83], v12, s[24:27], s56 offen sc1
  buffer_load_dwordx4 v[84:87], v13, s[24:27], s56 offen sc1
  buffer_load_dwordx4 v[88:91], v14, s[24:27], s56 offen sc1
  buffer_load_dwordx4 v[92:95], v15, s[24:27], s56 offen sc1
  s_add_u32 s56, s54, 4096
  buffer_load_dwordx4 v[96:99], v12, s[24:27], s56 offen sc1
  buffer_load_dwordx4 v[100:103], v13, s[24:27], s56 offen sc1
  buffer_load_dwordx4 v[104:107], v14, s[24:27], s56 offen sc1
  buffer_load_dwordx4 v[108:111], v15, s[24:27], s56 offen sc1
  s_add_u32 s56, s54, 8192
  buffer_load_dwordx4 v[112:115], v12, s[24:27], s56 offen sc1
  buffer_load_dwordx4 v[116:119], v13, s[24:27], s56 offen sc1
  buffer_load_dwordx4 v[120:123], v14, s[24:27], s56 offen sc1
  buffer_load_dwordx4 v[124:127], v15, s[24:27], s56 offen sc1
  s_sub_u32 s53, s3, 4
  s_lshl_b32 s57, s15, 10
  s_lshl_b32 s56, s53, 8
  s_add_u32 s57, s57, s56
  s_add_u32 s57, s57, 28344320
  v_and_b32 v6, 31, v0
  v_lshlrev_b32 v6, 3, v6
  v_add_u32 v6, s57, v6
  global_load_dwordx2 v[8:9], v6, s[8:9] sc0 sc1
  s_waitcnt vmcnt(9)
  v_mfma_f32_16x16x32_bf16 v[24:27], a[4:7], v[80:83], 0
  v_mfma_f32_16x16x32_bf16 a[88:91], a[4:7], v[84:87], 0
  v_mfma_f32_16x16x32_bf16 a[100:103], a[4:7], v[88:91], 0
  v_mfma_f32_16x16x32_bf16 a[108:111], a[4:7], v[92:95], 0
  v_mfma_f32_16x16x32_bf16 v[28:31], a[8:11], v[80:83], 0
  v_mfma_f32_16x16x32_bf16 a[92:95], a[8:11], v[84:87], 0
  v_mfma_f32_16x16x32_bf16 a[104:107], a[8:11], v[88:91], 0
  v_mfma_f32_16x16x32_bf16 a[0:3], a[8:11], v[92:95], 0
  v_mfma_f32_16x16x32_bf16 a[16:19], a[12:15], v[80:83], 0
  v_mfma_f32_16x16x32_bf16 a[48:51], a[12:15], v[84:87], 0
  v_mfma_f32_16x16x32_bf16 a[80:83], a[12:15], v[88:91], 0
  v_mfma_f32_16x16x32_bf16 v[32:35], a[12:15], v[92:95], 0
  v_mfma_f32_16x16x32_bf16 a[32:35], a[20:23], v[80:83], 0
  v_mfma_f32_16x16x32_bf16 a[64:67], a[20:23], v[84:87], 0
  v_mfma_f32_16x16x32_bf16 a[96:99], a[20:23], v[88:91], 0
  v_mfma_f32_16x16x32_bf16 v[36:39], a[20:23], v[92:95], 0
  s_waitcnt vmcnt(5)
  v_mfma_f32_16x16x32_bf16 v[24:27], a[24:27], v[96:99], v[24:27]
  v_mfma_f32_16x16x32_bf16 a[88:91], a[24:27], v[100:103], a[88:91]
  v_mfma_f32_16x16x32_bf16 a[100:103], a[24:27], v[104:107], a[100:103]
  v_mfma_f32_16x16x32_bf16 a[108:111], a[24:27], v[108:111], a[108:111]
  v_mfma_f32_16x16x32_bf16 v[28:31], a[28:31], v[96:99], v[28:31]
  v_mfma_f32_16x16x32_bf16 a[92:95], a[28:31], v[100:103], a[92:95]
  v_mfma_f32_16x16x32_bf16 a[104:107], a[28:31], v[104:107], a[104:107]
  v_mfma_f32_16x16x32_bf16 a[0:3], a[28:31], v[108:111], a[0:3]
  v_mfma_f32_16x16x32_bf16 a[16:19], a[36:39], v[96:99], a[16:19]
  v_mfma_f32_16x16x32_bf16 a[48:51], a[36:39], v[100:103], a[48:51]
  v_mfma_f32_16x16x32_bf16 a[80:83], a[36:39], v[104:107], a[80:83]
  v_mfma_f32_16x16x32_bf16 v[32:35], a[36:39], v[108:111], v[32:35]
  v_mfma_f32_16x16x32_bf16 a[32:35], a[40:43], v[96:99], a[32:35]
  v_mfma_f32_16x16x32_bf16 a[64:67], a[40:43], v[100:103], a[64:67]
  v_mfma_f32_16x16x32_bf16 a[96:99], a[40:43], v[104:107], a[96:99]
  v_mfma_f32_16x16x32_bf16 v[36:39], a[40:43], v[108:111], v[36:39]
  s_waitcnt vmcnt(1)
  v_mfma_f32_16x16x32_bf16 v[24:27], a[44:47], v[112:115], v[24:27]
  v_mfma_f32_16x16x32_bf16 a[88:91], a[44:47], v[116:119], a[88:91]
  v_mfma_f32_16x16x32_bf16 a[100:103], a[44:47], v[120:123], a[100:103]
  v_mfma_f32_16x16x32_bf16 a[108:111], a[44:47], v[124:127], a[108:111]
  v_mfma_f32_16x16x32_bf16 v[28:31], a[52:55], v[112:115], v[28:31]
  v_mfma_f32_16x16x32_bf16 a[92:95], a[52:55], v[116:119], a[92:95]
  v_mfma_f32_16x16x32_bf16 a[104:107], a[52:55], v[120:123], a[104:107]
  v_mfma_f32_16x16x32_bf16 a[0:3], a[52:55], v[124:127], a[0:3]
  v_mfma_f32_16x16x32_bf16 a[16:19], a[56:59], v[112:115], a[16:19]
  v_mfma_f32_16x16x32_bf16 a[48:51], a[56:59], v[116:119], a[48:51]
  v_mfma_f32_16x16x32_bf16 a[80:83], a[56:59], v[120:123], a[80:83]
  v_mfma_f32_16x16x32_bf16 v[32:35], a[56:59], v[124:127], v[32:35]
  v_mfma_f32_16x16x32_bf16 a[32:35], a[60:63], v[112:115], a[32:35]
  v_mfma_f32_16x16x32_bf16 a[64:67], a[60:63], v[116:119], a[64:67]
  v_mfma_f32_16x16x32_bf16 a[96:99], a[60:63], v[120:123], a[96:99]
  v_mfma_f32_16x16x32_bf16 v[36:39], a[60:63], v[124:127], v[36:39]
  s_waitcnt vmcnt(0)
  v_cmp_ne_u64 vcc, s[96:97], v[8:9]
  s_nop 1
  s_cmp_eq_u64 vcc, 0
  s_cbranch_scc1 p3_y_ok
  s_mov_b32 exec_lo, 0xffffffff
  s_mov_b32 exec_hi, 0xffffffff
  s_mov_b32 s95, 0
p3_y:
  global_load_dwordx2 v[8:9], v6, s[8:9] sc0 sc1
  s_add_u32 s95, s95, 1
  s_waitcnt vmcnt(0)
  v_cmp_ne_u64 vcc, s[96:97], v[8:9]
  s_nop 1
  s_cmp_eq_u64 vcc, 0
  s_cbranch_scc1 p3_y_ok
  s_sleep 2
  s_cmp_lt_u32 s95, 0x100000
  s_cbranch_scc1 p3_y
p3_y_ok:
  s_mov_b64 exec, -1
  s_lshl_b32 s56, s15, 18
  s_lshl_b32 s57, s53, 16
  s_add_u32 s56, s56, s57
  s_lshl_b32 s57, s14, 7
  s_add_u32 s60, s56, s57
  s_lshl_b32 s57, s53, 11
  s_add_u32 m0, s57, 114688
  s_add_u32 s61, s60, 32768
  buffer_load_dwordx4 v3, s[32:35], s60 offen sc1 lds
  s_add_u32 m0, s57, 115712
  s_nop 0
  buffer_load_dwordx4 v3, s[32:35], s61 offen sc1 lds
p3_red:
  s_mul_i32 s52, s3, 14336
  v_add_u32 v2, s52, v10
  ds_write_b128 v2, a[88:91] offset:0
  ds_write_b128 v2, a[92:95] offset:1024
  ds_write_b128 v2, a[100:103] offset:2048
  ds_write_b128 v2, a[104:107] offset:3072
  ds_write_b128 v2, a[108:111] offset:4096
  ds_write_b128 v2, a[0:3] offset:5120
  ds_write_b128 v2, a[16:19] offset:6144
  ds_write_b128 v2, a[32:35] offset:7168
  ds_write_b128 v2, a[48:51] offset:8192
  ds_write_b128 v2, a[64:67] offset:9216
  ds_write_b128 v2, a[80:83] offset:10240
  ds_write_b128 v2, a[96:99] offset:11264
  ds_write_b128 v2, v[32:35] offset:12288
  ds_write_b128 v2, v[36:39] offset:13312
  s_waitcnt vmcnt(0) lgkmcnt(0)
  s_barrier
  s_sub_u32 s53, s3, 1
  s_and_b32 s53, s53, 3
  s_xor_b32 s57, s59, 0
  s_lshl_b32 s57, s57, 2
  s_add_u32 s53, s53, s57
  s_mul_i32 s53, s53, 14336
  v_add_u32 v2, s53, v10
  ds_read_b128 v[40:43], v2 offset:0
  ds_read_b128 v[44:47], v2 offset:1024
  s_sub_u32 s53, s3, 2
  s_and_b32 s53, s53, 3
  s_xor_b32 s57, s59, 0
  s_lshl_b32 s57, s57, 2
  s_add_u32 s53, s53, s57
  s_mul_i32 s53, s53, 14336
  v_add_u32 v3, s53, v10
  ds_read_b128 v[48:51], v3 offset:2048
  ds_read_b128 v[52:55], v3 offset:3072
  s_sub_u32 s53, s3, 3
  s_and_b32 s53, s53, 3
  s_xor_b32 s57, s59, 0
  s_lshl_b32 s57, s57, 2
  s_add_u32 s53, s53, s57
  s_mul_i32 s53, s53, 14336
  v_add_u32 v2, s53, v10
  ds_read_b128 v[56:59], v2 offset:4096
  ds_read_b128 v[60:63], v2 offset:5120
  s_sub_u32 s53, s3, 0
  s_and_b32 s53, s53, 3
  s_xor_b32 s57, s59, 1
  s_lshl_b32 s57, s57, 2
  s_add_u32 s53, s53, s57
  s_mul_i32 s53, s53, 14336
  v_add_u32 v3, s53, v10
  ds_read_b128 v[64:67], v3 offset:6144
  ds_read_b128 v[68:71], v3 offset:7168
  s_sub_u32 s53, s3, 1
  s_and_b32 s53, s53, 3
  s_xor_b32 s57, s59, 1
  s_lshl_b32 s57, s57, 2
  s_add_u32 s53, s53, s57
  s_mul_i32 s53, s53, 14336
  v_add_u32 v2, s53, v10
  ds_read_b128 v[72:75], v2 offset:8192
  ds_read_b128 v[76:79], v2 offset:9216
  s_sub_u32 s53, s3, 2
  s_and_b32 s53, s53, 3
  s_xor_b32 s57, s59, 1
  s_lshl_b32 s57, s57, 2
  s_add_u32 s53, s53, s57
  s_mul_i32 s53, s53, 14336
  v_add_u32 v3, s53, v10
  ds_read_b128 v[80:83], v3 offset:10240
  ds_read_b128 v[84:87], v3 offset:11264
  s_sub_u32 s53, s3, 3
  s_and_b32 s53, s53, 3
  s_xor_b32 s57, s59, 1
  s_lshl_b32 s57, s57, 2
  s_add_u32 s53, s53, s57
  s_mul_i32 s53, s53, 14336
  v_add_u32 v2, s53, v10
  ds_read_b128 v[88:91], v2 offset:12288
  ds_read_b128 v[92:95], v2 offset:13312
  v_lshrrev_b32 v4, 4, v0
  v_bfe_u32 v5, v0, 2, 2
  v_and_b32 v6, 3, v0
  v_lshl_add_u32 v4, v4, 3, v5
  v_lshlrev_b32 v4, 7, v4
  v_lshl_add_u32 v4, v6, 3, v4
  s_and_b32 s53, s3, 3
  s_lshl_b32 s53, s53, 5
  s_lshl_b32 s57, s59, 12
  s_add_u32 s53, s53, s57
  s_add_u32 s53, s53, 114688
  v_add_u32 v4, s53, v4
  s_waitcnt lgkmcnt(0)
  ds_read_b64_tr_b16 v[32:33], v4 offset:0
  ds_read_b64_tr_b16 v[34:35], v4 offset:512
  v_add_f32 v24, v24, v40
  v_add_f32 v48, v48, v56
  v_add_f32 v64, v64, v72
  v_add_f32 v80, v80, v88
  v_add_f32 v25, v25, v41
  v_add_f32 v49, v49, v57
  v_add_f32 v65, v65, v73
  v_add_f32 v81, v81, v89
  v_add_f32 v26, v26, v42
  v_add_f32 v50, v50, v58
  v_add_f32 v66, v66, v74
  v_add_f32 v82, v82, v90
  v_add_f32 v27, v27, v43
  v_add_f32 v51, v51, v59
  v_add_f32 v67, v67, v75
  v_add_f32 v83, v83, v91
  v_add_f32 v28, v28, v44
  v_add_f32 v52, v52, v60
  v_add_f32 v68, v68, v76
  v_add_f32 v84, v84, v92
  v_add_f32 v29, v29, v45
  v_add_f32 v53, v53, v61
  v_add_f32 v69, v69, v77
  v_add_f32 v85, v85, v93
  v_add_f32 v30, v30, v46
  v_add_f32 v54, v54, v62
  v_add_f32 v70, v70, v78
  v_add_f32 v86, v86, v94
  v_add_f32 v31, v31, v47
  v_add_f32 v55, v55, v63
  v_add_f32 v71, v71, v79
  v_add_f32 v87, v87, v95
  v_add_f32 v24, v24, v48
  v_add_f32 v64, v64, v80
  v_add_f32 v25, v25, v49
  v_add_f32 v65, v65, v81
  v_add_f32 v26, v26, v50
  v_add_f32 v66, v66, v82
  v_add_f32 v27, v27, v51
  v_add_f32 v67, v67, v83
  v_add_f32 v28, v28, v52
  v_add_f32 v68, v68, v84
  v_add_f32 v29, v29, v53
  v_add_f32 v69, v69, v85
  v_add_f32 v30, v30, v54
  v_add_f32 v70, v70, v86
  v_add_f32 v31, v31, v55
  v_add_f32 v71, v71, v87
  v_add_f32 v24, v24, v64
  v_add_f32 v25, v25, v65
  v_add_f32 v26, v26, v66
  v_add_f32 v27, v27, v67
  v_add_f32 v28, v28, v68
  v_add_f32 v29, v29, v69
  v_add_f32 v30, v30, v70
  v_add_f32 v31, v31, v71
  s_mov_b32 s65, 0xffff0000
  s_waitcnt lgkmcnt(0)
  v_cvt_pk_bf16_f32 v2, v24, v25
  v_lshlrev_b32 v4, 16, v20
  v_and_b32 v5, s65, v20
  v_lshlrev_b32 v6, 16, v32
  v_and_b32 v7, s65, v32
  v_add_f32 v4, v4, v6
  v_add_f32 v5, v5, v7
  v_cvt_pk_bf16_f32 v6, v4, v5
  v_lshlrev_b32 v4, 16, v6
  v_and_b32 v5, s65, v6
  v_lshlrev_b32 v6, 16, v2
  v_and_b32 v7, s65, v2
  v_add_f32 v4, v4, v6
  v_add_f32 v5, v5, v7
  v_cvt_pk_bf16_f32 v40, v4, v5
  v_cvt_pk_bf16_f32 v2, v26, v27
  v_lshlrev_b32 v4, 16, v21
  v_and_b32 v5, s65, v21
  v_lshlrev_b32 v6, 16, v33
  v_and_b32 v7, s65, v33
  v_add_f32 v4, v4, v6
  v_add_f32 v5, v5, v7
  v_cvt_pk_bf16_f32 v6, v4, v5
  v_lshlrev_b32 v4, 16, v6
  v_and_b32 v5, s65, v6
  v_lshlrev_b32 v6, 16, v2
  v_and_b32 v7, s65, v2
  v_add_f32 v4, v4, v6
  v_add_f32 v5, v5, v7
  v_cvt_pk_bf16_f32 v41, v4, v5
  v_cvt_pk_bf16_f32 v2, v28, v29
  v_lshlrev_b32 v4, 16, v22
  v_and_b32 v5, s65, v22
  v_lshlrev_b32 v6, 16, v34
  v_and_b32 v7, s65, v34
  v_add_f32 v4, v4, v6
  v_add_f32 v5, v5, v7
  v_cvt_pk_bf16_f32 v6, v4, v5
  v_lshlrev_b32 v4, 16, v6
  v_and_b32 v5, s65, v6
  v_lshlrev_b32 v6, 16, v2
  v_and_b32 v7, s65, v2
  v_add_f32 v4, v4, v6
  v_add_f32 v5, v5, v7
  v_cvt_pk_bf16_f32 v42, v4, v5
  v_cvt_pk_bf16_f32 v2, v30, v31
  v_lshlrev_b32 v4, 16, v23
  v_and_b32 v5, s65, v23
  v_lshlrev_b32 v6, 16, v35
  v_and_b32 v7, s65, v35
  v_add_f32 v4, v4, v6
  v_add_f32 v5, v5, v7
  v_cvt_pk_bf16_f32 v6, v4, v5
  v_lshlrev_b32 v4, 16, v6
  v_and_b32 v5, s65, v6
  v_lshlrev_b32 v6, 16, v2
  v_and_b32 v7, s65, v2
  v_add_f32 v4, v4, v6
  v_add_f32 v5, v5, v7
  v_cvt_pk_bf16_f32 v43, v4, v5
  buffer_store_dwordx4 v[40:43], v11, s[20:23], s58 offen sc1
f_end:
  s_endpgm

.section .rodata,"a"
.p2align 6
.amdhsa_kernel parallel_sum__ssm_conv_s4__mixer_gmlp__prompt_kernel
  .amdhsa_next_free_vgpr 256
  .amdhsa_next_free_sgpr 102
  .amdhsa_accum_offset 144
  .amdhsa_group_segment_fixed_size 0
  .amdhsa_kernarg_size 136
  .amdhsa_user_sgpr_count 2
  .amdhsa_user_sgpr_kernarg_segment_ptr 1
  .amdhsa_system_sgpr_workgroup_id_x 1
.end_amdhsa_kernel
```
